```python
import torch

def _softmax(x, axis=-1):
    return torch.softmax(x, dim=axis)
def _gelu(x):
    return torch.nn.functional.gelu(x, approximate="tanh")
def _silu(x):
    return torch.nn.functional.silu(x)
def _sigmoid(x):
    return torch.sigmoid(x)
def _layernorm(x, axis=-1, eps=1e-5):
    m = x.mean(dim=axis, keepdim=True)
    v = x.var(dim=axis, keepdim=True, unbiased=False)
    return (x - m) / torch.sqrt(v + eps)
def _scatter_add(tgt, idx, src, axis=0):
    return tgt.clone().index_add_(axis, idx, src)
def _segment_sum(src, seg, n):
    out = torch.zeros((n,) + src.shape[1:], dtype=src.dtype)
    return out.index_add_(0, seg, src)
def _pad(x, pw):
    flat = tuple(v for pair in reversed(pw) for v in pair)
    return torch.nn.functional.pad(x, flat)

kernel_name = 'standalone__batchnorm__prompt'

def setup_inputs():

    _w = (lambda a: (lambda t: t.to(torch.bfloat16) if t.is_floating_point() else t)(torch.as_tensor(a)))
    B, S, C = 2, 2048, 1024
    K = 3
    return {
        "x": _w((lambda *s: torch.randn(*s, dtype=torch.bfloat16) * 0.05)(B, S, C)),
        "w": _w((lambda *s: torch.randn(*s, dtype=torch.bfloat16) * 0.05)(K, C, C) * (1.0 / (K * C) ** 0.5)),
        "mean": _w((lambda *s: torch.randn(*s, dtype=torch.bfloat16) * 0.05)(C) * 0.1),
        "var": _w(torch.abs((lambda *s: torch.randn(*s, dtype=torch.bfloat16) * 0.05)(C)) + 0.5),
        "g": _w((lambda *s: torch.randn(*s, dtype=torch.bfloat16) * 0.05)(C) + 1.0),
        "b": _w((lambda *s: torch.randn(*s, dtype=torch.bfloat16) * 0.05)(C) * 0.1),
    }

def reference(x, w, mean, var, g, b):
    K = 3
    P = K // 2
    S = x.shape[1]
    xp = _pad(x, ((0, 0), (P, P), (0, 0)))
    y = sum(torch.einsum('bsc,cd->bsd', xp[:, k:k + S, :], w[k]) for k in range(K))
    inv_std = 1.0 / torch.sqrt(var + 1e-5)
    y = (y - mean) * (g * inv_std) + b
    return _silu(y)
```

```asm
; @launch grid=(256,1,1) block=(512,1,1) lds=163840
.amdgcn_target "amdgcn-amd-amdhsa--gfx950"
.text
.globl standalone__batchnorm__prompt_kernel
.p2align 8
.type standalone__batchnorm__prompt_kernel,@function
standalone__batchnorm__prompt_kernel:
s_load_dwordx4 s[44:47], s[0:1], 0
s_cmp_ge_u32 s2, 256
s_cbranch_scc1 L_end
v_lshrrev_b32 v2, 6, v0
v_and_b32 v1, 63, v0
v_readfirstlane_b32 s42, v2
s_andn2_b32 s40, 1, s2
s_bfe_u32 s41, s2, 0x30003
s_and_b32 s39, s41, 6
s_lshl1_add_u32 s39, s40, s39
s_add_u32 s26, s39, s41
s_lshl_b32 s26, s26, 6
s_lshr_b32 s7, s41, 1
s_and_b32 s24, s42, 3
s_cmp_lt_u32 s42, 4
s_cbranch_scc1 L_load
s_lshr_b32 s40, s2, 1
v_and_b32 v2, 3, v2
s_getpc_b64 s[4:5]
L_pc:
s_and_b32 s39, s40, 124
v_add_lshl_u32 v4, v2, s39, 7
v_min_u32 v4, L_end-L_pc, v4
v_add_co_u32 v4, vcc, s4, v4
v_mov_b32 v5, s5
s_nop 0
v_addc_co_u32 v5, vcc, 0, v5, vcc
global_load_dword v31, v[4:5], off
s_branch L_compute
L_load:
v_lshrrev_b32 v2, 3, v1
v_and_b32 v4, 7, v1
s_and_b32 s40, s24, 1
v_bfe_u32 v3, v1, 4, 1
v_lshl_or_b32 v3, s40, 1, v3
v_lshlrev_b32 v3, 1, v3
v_xor_b32 v3, v3, v4
v_lshlrev_b32 v3, 4, v3
v_lshl_add_u32 v3, v2, 11, v3
s_lshl_b32 s39, s24, 14
s_lshl1_add_u32 s39, s26, s39
s_add_u32 s39, s39, 2098176
s_bfe_u32 s4, s2, 65542
s_cselect_b32 s40, -1, 1
s_lshl_b32 s40, s40, 21
s_sub_u32 s40, s40, 1024
v_add_u32 v13, s39, v3
v_subrev_u32 v12, s40, v13
v_add_u32 v14, s40, v13
s_mul_i32 s38, s24, 3072
s_mov_b32 s14, 6293504
s_mov_b32 s15, 0x20000
s_mov_b32 s36, 524288
s_and_b32 s101, s2, 128
s_lshl_b32 s101, s101, 9
s_and_b32 s39, s26, 448
s_cmp_eq_u32 s39, 192
s_cselect_b32 s6, s101, 0
s_xor_b32 s32, s36, s6
s_bfe_u32 s39, s2, 0x20001
s_lshr_b32 s40, s2, 6
s_lshl2_add_u32 s25, s39, s40
s_lshl_b32 s25, s25, 8
s_lshl_b32 s5, s4, 12
s_add_u32 s10, s5, 8389632
s_mov_b32 s11, 0x20000
s_mov_b32 s35, 512
s_add_u32 s33, s35, s5
v_and_b32 v3, 6, v2
v_xor_b32 v3, v3, v4
v_lshlrev_b32 v3, 4, v3
v_lshl_add_u32 v3, v2, 14, v3
s_lshl1_add_u32 s39, s24, s25
s_lshl_b32 s39, s39, 11
s_lshl_b32 s40, s7, 17
s_add_u32 s39, s39, s40
s_add_u32 s39, s39, 1024
s_mul_i32 s40, s4, 522240
s_xor_b32 s39, s39, s40
v_xor_b32 v8, s39, v3
v_xor_b32 v9, 132096, v8
v_xor_b32 v10, 262144, v8
v_xor_b32 v11, 394240, v8
s_lshl_b32 s37, s24, 12
s_waitcnt lgkmcnt(0)
s_sub_u32 s12, s46, 2048
s_subb_u32 s13, s47, 0
s_add_u32 s39, s5, 1024
s_sub_u32 s8, s44, s39
s_subb_u32 s9, s45, 0
s_add_u32 m0, s38, 102400
s_nop 0
buffer_load_dwordx4 v12, s[12:15], s32 offen offset:0 lds
buffer_load_dwordx4 v13, s[12:15], s32 offen offset:1024 lds
buffer_load_dwordx4 v14, s[12:15], s32 offen offset:2048 lds
s_add_u32 s36, s36, 65536
s_and_b32 s36, s36, 0x1fffff
s_xor_b32 s32, s36, s6
s_add_u32 m0, s37, 0
s_nop 0
buffer_load_dwordx4 v8, s[8:11], s33 offen offset:0 lds
buffer_load_dwordx4 v8, s[8:11], s35 offen offset:2048 lds
buffer_load_dwordx4 v9, s[8:11], s33 offen offset:1024 lds
buffer_load_dwordx4 v9, s[8:11], s35 offen offset:3072 lds
s_add_u32 s39, s25, 256
s_lshl_b32 s42, s39, 11
s_and_b32 s40, s39, 2047
s_cselect_b32 s39, s42, 0x40000000
s_sub_u32 s41, s42, 526336
s_and_b32 s40, s25, 2047
s_cselect_b32 s41, s41, 0x40000000
v_and_b32 v3, 1, v2
v_cmp_ne_u32 vcc, s4, v3
v_mov_b32 v5, s39
v_mov_b32 v6, s41
v_mul_u32_u24 v3, 6, v3
v_cndmask_b32 v5, v5, v6, vcc
v_xor_b32 v3, v3, v4
v_lshl_add_u32 v5, v3, 4, v5
v_lshrrev_b32 v3, 4, v1
v_lshl_add_u32 v15, v3, 7, v5
s_cmp_eq_u32 s24, 1
s_cbranch_scc0 L_c1
s_lshl_b32 s39, s24, 10
s_add_u32 m0, s39, 98304
s_lshl_b32 s39, s24, 9
s_add_u32 s39, s39, 1024
s_add_u32 s39, s39, s5
buffer_load_dwordx4 v15, s[8:11], s39 offen lds
L_c1:
s_add_u32 m0, s37, 16384
s_nop 0
buffer_load_dwordx4 v10, s[8:11], s33 offen offset:0 lds
buffer_load_dwordx4 v10, s[8:11], s35 offen offset:2048 lds
buffer_load_dwordx4 v11, s[8:11], s33 offen offset:1024 lds
buffer_load_dwordx4 v11, s[8:11], s35 offen offset:3072 lds
s_add_u32 s35, s35, 128
s_and_b32 s35, s35, 2047
s_add_u32 s33, s35, s5
s_lshr_b32 s39, s2, 3
s_lshl_b32 s40, s24, 5
s_add_u32 s39, s39, s40
s_add_u32 s39, s39, 56
s_and_b32 s39, s39, 127
s_lshl_b32 s39, s39, 14
s_add_u32 s39, s39, 384
v_min_u32 v5, 47, v1
v_lshrrev_b32 v6, 4, v5
v_and_b32 v5, 15, v5
v_lshl_add_u32 v5, v5, 10, s39
s_bitcmp1_b32 s26, 7
s_cselect_b32 s3, s24, 20
v_lshl_add_u32 v19, v6, 21, v5
s_cmp_eq_u32 s24, 3
s_cselect_b32 s3, 20, s3
s_lshl_b32 s43, s3, 2
s_sub_u32 s43, s43, 2
s_bfe_u32 s39, s2, 0x30003
s_lshl_b32 s39, s39, 5
s_add_u32 s39, s39, s25
s_lshl_b32 s39, s39, 11
s_add_u32 s39, s39, s5
v_min_u32 v5, 31, v1
v_lshl_add_u32 v52, v5, 11, s39
s_mov_b32 s31, 384
s_cmp_eq_u32 s24, 0
s_cselect_b32 s29, 10, 99
s_lshr_b32 s39, s2, 6
s_lshl2_add_u32 s39, s39, s24
s_lshl_b32 s39, s39, 13
s_lshl1_add_u32 s39, s26, s39
v_min_u32 v5, 11, v1
v_lshrrev_b32 v6, 2, v5
v_and_b32 v5, 3, v5
v_lshl_add_u32 v5, v5, 11, s39
v_lshl_add_u32 v53, v6, 21, v5
s_load_dwordx8 s[48:55], s[0:1], 16
s_load_dwordx4 s[56:59], s[0:1], 48
v_lshrrev_b32 v2, 3, v1
v_and_b32 v3, 7, v1
v_lshlrev_b32 v4, 1, v3
v_xor_b32 v4, v4, v2
v_lshlrev_b32 v4, 4, v4
v_lshl_add_u32 v4, v2, 8, v4
s_lshl_b32 s39, s24, 11
s_add_u32 s39, s39, 32768
v_add_u32 v16, s39, v4
v_xor_b32 v17, 16, v16
s_lshl_b32 s39, s24, 6
s_add_u32 s39, s39, s25
s_lshl_b32 s39, s39, 11
s_lshl1_add_u32 s39, s26, s39
v_lshlrev_b32 v3, 4, v3
v_lshl_add_u32 v3, v2, 14, v3
s_mul_i32 s40, s4, 507904
s_xor_b32 s39, s39, s40
v_xor_b32 v18, s39, v3
s_mul_i32 s34, s4, 14336
s_lshl_b32 s39, s24, 9
s_add_u32 s39, s39, 57344
v_lshl_add_u32 v54, v1, 2, s39
v_and_b32 v55, 7, v1
v_lshl_add_u32 v55, v55, 5, s39
s_add_u32 m0, s38, 114688
s_nop 0
buffer_load_dwordx4 v12, s[12:15], s32 offen offset:0 lds
buffer_load_dwordx4 v13, s[12:15], s32 offen offset:1024 lds
buffer_load_dwordx4 v14, s[12:15], s32 offen offset:2048 lds
s_add_u32 s36, s36, 65536
s_and_b32 s36, s36, 0x1fffff
s_xor_b32 s32, s36, s101
s_add_u32 m0, s38, 126976
s_nop 0
buffer_load_dwordx4 v12, s[12:15], s32 offen offset:0 lds
buffer_load_dwordx4 v13, s[12:15], s32 offen offset:1024 lds
buffer_load_dwordx4 v14, s[12:15], s32 offen offset:2048 lds
s_add_u32 s36, s36, 65536
s_and_b32 s36, s36, 0x1fffff
s_xor_b32 s32, s36, s101
s_add_u32 m0, s37, 32768
s_nop 0
buffer_load_dwordx4 v8, s[8:11], s33 offen offset:0 lds
buffer_load_dwordx4 v8, s[8:11], s35 offen offset:2048 lds
s_waitcnt vmcnt(8)
s_barrier
s_add_u32 m0, s37, 32768
s_nop 0
buffer_load_dwordx4 v9, s[8:11], s33 offen offset:1024 lds
buffer_load_dwordx4 v9, s[8:11], s35 offen offset:3072 lds
s_add_u32 m0, s37, 49152
s_nop 0
buffer_load_dwordx4 v10, s[8:11], s33 offen offset:0 lds
buffer_load_dwordx4 v10, s[8:11], s35 offen offset:2048 lds
buffer_load_dwordx4 v11, s[8:11], s33 offen offset:1024 lds
buffer_load_dwordx4 v11, s[8:11], s35 offen offset:3072 lds
s_add_u32 s35, s35, 128
s_and_b32 s35, s35, 2047
s_add_u32 s33, s35, s5
s_waitcnt vmcnt(11)
s_barrier
s_add_u32 m0, s38, 139264
s_nop 0
buffer_load_dwordx4 v12, s[12:15], s32 offen offset:0 lds
buffer_load_dwordx4 v13, s[12:15], s32 offen offset:1024 lds
buffer_load_dwordx4 v14, s[12:15], s32 offen offset:2048 lds
s_add_u32 s36, s36, 65536
s_and_b32 s36, s36, 0x1fffff
s_xor_b32 s32, s36, s101
s_cmp_eq_u32 s3, 0
s_cbranch_scc0 L_c2
buffer_load_dword v31, v19, s[12:15], 0 offen offset:2048
L_c2:
s_add_u32 m0, s38, 151552
s_nop 0
buffer_load_dwordx4 v12, s[12:15], s32 offen offset:0 lds
buffer_load_dwordx4 v13, s[12:15], s32 offen offset:1024 lds
buffer_load_dwordx4 v14, s[12:15], s32 offen offset:2048 lds
s_add_u32 s36, s36, 65536
s_and_b32 s36, s36, 0x1fffff
s_xor_b32 s32, s36, s101
s_add_u32 m0, s37, 65536
s_nop 0
buffer_load_dwordx4 v8, s[8:11], s33 offen offset:0 lds
buffer_load_dwordx4 v8, s[8:11], s35 offen offset:2048 lds
s_waitcnt vmcnt(8)
s_barrier
s_add_u32 m0, s37, 65536
s_nop 0
buffer_load_dwordx4 v9, s[8:11], s33 offen offset:1024 lds
buffer_load_dwordx4 v9, s[8:11], s35 offen offset:3072 lds
s_add_u32 m0, s37, 81920
s_nop 0
buffer_load_dwordx4 v10, s[8:11], s33 offen offset:0 lds
buffer_load_dwordx4 v10, s[8:11], s35 offen offset:2048 lds
buffer_load_dwordx4 v11, s[8:11], s33 offen offset:1024 lds
buffer_load_dwordx4 v11, s[8:11], s35 offen offset:3072 lds
s_add_u32 s35, s35, 128
s_and_b32 s35, s35, 2047
s_add_u32 s33, s35, s5
s_waitcnt vmcnt(11)
s_barrier
s_add_u32 m0, s38, 102400
s_nop 0
buffer_load_dwordx4 v12, s[12:15], s32 offen offset:0 lds
buffer_load_dwordx4 v13, s[12:15], s32 offen offset:1024 lds
buffer_load_dwordx4 v14, s[12:15], s32 offen offset:2048 lds
s_add_u32 s36, s36, 65536
s_and_b32 s36, s36, 0x1fffff
s_xor_b32 s32, s36, s101
s_add_u32 m0, s38, 114688
s_nop 0
buffer_load_dwordx4 v12, s[12:15], s32 offen offset:0 lds
buffer_load_dwordx4 v13, s[12:15], s32 offen offset:1024 lds
buffer_load_dwordx4 v14, s[12:15], s32 offen offset:2048 lds
s_add_u32 s36, s36, 65536
s_and_b32 s36, s36, 0x1fffff
s_xor_b32 s32, s36, s101
s_add_u32 m0, s37, 0
s_nop 0
buffer_load_dwordx4 v8, s[8:11], s33 offen offset:0 lds
buffer_load_dwordx4 v8, s[8:11], s35 offen offset:2048 lds
buffer_load_dwordx4 v9, s[8:11], s33 offen offset:1024 lds
buffer_load_dwordx4 v9, s[8:11], s35 offen offset:3072 lds
s_add_u32 m0, s37, 16384
s_nop 0
buffer_load_dwordx4 v10, s[8:11], s33 offen offset:0 lds
buffer_load_dwordx4 v10, s[8:11], s35 offen offset:2048 lds
buffer_load_dwordx4 v11, s[8:11], s33 offen offset:1024 lds
buffer_load_dwordx4 v11, s[8:11], s35 offen offset:3072 lds
s_add_u32 s35, s35, 128
s_and_b32 s35, s35, 2047
s_add_u32 s33, s35, s5
s_waitcnt vmcnt(11)
s_barrier
s_cmp_lg_u32 s24, 1
s_cbranch_scc0 L_c3
s_lshl_b32 s39, s24, 10
s_add_u32 m0, s39, 98304
s_lshl_b32 s39, s24, 9
s_add_u32 s39, s39, 1024
s_add_u32 s39, s39, s5
buffer_load_dwordx4 v15, s[8:11], s39 offen lds
L_c3:
s_add_u32 m0, s38, 126976
s_nop 0
buffer_load_dwordx4 v12, s[12:15], s32 offen offset:0 lds
buffer_load_dwordx4 v13, s[12:15], s32 offen offset:1024 lds
buffer_load_dwordx4 v14, s[12:15], s32 offen offset:2048 lds
s_add_u32 s36, s36, 65536
s_and_b32 s36, s36, 0x1fffff
s_xor_b32 s32, s36, s101
s_add_u32 m0, s38, 139264
s_nop 0
buffer_load_dwordx4 v12, s[12:15], s32 offen offset:0 lds
buffer_load_dwordx4 v13, s[12:15], s32 offen offset:1024 lds
buffer_load_dwordx4 v14, s[12:15], s32 offen offset:2048 lds
s_add_u32 s36, s36, 65536
s_and_b32 s36, s36, 0x1fffff
s_xor_b32 s32, s36, s101
s_add_u32 m0, s37, 32768
s_nop 0
buffer_load_dwordx4 v8, s[8:11], s33 offen offset:0 lds
buffer_load_dwordx4 v8, s[8:11], s35 offen offset:2048 lds
buffer_load_dwordx4 v9, s[8:11], s33 offen offset:1024 lds
buffer_load_dwordx4 v9, s[8:11], s35 offen offset:3072 lds
s_add_u32 m0, s37, 49152
s_nop 0
buffer_load_dwordx4 v10, s[8:11], s33 offen offset:0 lds
buffer_load_dwordx4 v10, s[8:11], s35 offen offset:2048 lds
buffer_load_dwordx4 v11, s[8:11], s33 offen offset:1024 lds
buffer_load_dwordx4 v11, s[8:11], s35 offen offset:3072 lds
s_add_u32 s35, s35, 128
s_and_b32 s35, s35, 2047
s_add_u32 s33, s35, s5
s_mov_b32 s28, 65536
s_mov_b32 s30, 151552
s_mov_b32 s27, 2
s_waitcnt lgkmcnt(0)
L_lloop:
s_waitcnt vmcnt(11)
L_lbar:
s_barrier
s_cmp_eq_u32 s27, s43
s_cbranch_scc0 L_c4
buffer_load_dword v31, v19, s[12:15], 0 offen offset:2048
L_c4:
s_cmp_eq_u32 s27, s29
s_cbranch_scc0 L_c5
buffer_load_dword v31, v52, s[8:11], s31 offen offset:1024
L_c5:
s_cmp_eq_u32 s27, 9
s_cbranch_scc0 L_c6
s_mov_b32 s39, 393216
buffer_load_dword v31, v53, s[12:15], s39 offen offset:2048
L_c6:
s_add_u32 m0, s30, s38
s_add_u32 s27, s27, 1
buffer_load_dwordx4 v12, s[12:15], s32 offen offset:0 lds
buffer_load_dwordx4 v13, s[12:15], s32 offen offset:1024 lds
buffer_load_dwordx4 v14, s[12:15], s32 offen offset:2048 lds
s_add_u32 s36, s36, 65536
s_and_b32 s36, s36, 0x1fffff
s_xor_b32 s32, s36, s101
s_add_u32 s30, s30, 12288
s_cmp_eq_u32 s30, 163840
s_cselect_b32 s30, 102400, s30
s_add_u32 m0, s30, s38
s_nop 0
buffer_load_dwordx4 v12, s[12:15], s32 offen offset:0 lds
buffer_load_dwordx4 v13, s[12:15], s32 offen offset:1024 lds
buffer_load_dwordx4 v14, s[12:15], s32 offen offset:2048 lds
s_add_u32 s36, s36, 65536
s_and_b32 s36, s36, 0x1fffff
s_xor_b32 s32, s36, s101
s_add_u32 s30, s30, 12288
s_cmp_eq_u32 s30, 163840
s_cselect_b32 s30, 102400, s30
s_add_u32 m0, s28, s37
s_nop 0
buffer_load_dwordx4 v8, s[8:11], s33 offen offset:0 lds
buffer_load_dwordx4 v8, s[8:11], s35 offen offset:2048 lds
buffer_load_dwordx4 v9, s[8:11], s33 offen offset:1024 lds
buffer_load_dwordx4 v9, s[8:11], s35 offen offset:3072 lds
s_add_u32 m0, m0, 16384
s_add_u32 s28, s28, 32768
s_cmp_eq_u32 s28, 98304
s_cselect_b32 s28, 0, s28
buffer_load_dwordx4 v10, s[8:11], s33 offen offset:0 lds
buffer_load_dwordx4 v10, s[8:11], s35 offen offset:2048 lds
buffer_load_dwordx4 v11, s[8:11], s33 offen offset:1024 lds
buffer_load_dwordx4 v11, s[8:11], s35 offen offset:3072 lds
s_add_u32 s35, s35, 128
s_and_b32 s35, s35, 2047
s_add_u32 s33, s35, s5
s_cmp_eq_u32 s27, 8
s_cbranch_scc1 L_pre0
s_cmp_eq_u32 s27, 6
s_cbranch_scc1 L_pre1
s_cmp_lt_u32 s27, 13
s_cbranch_scc1 L_lloop
s_add_u32 m0, s30, s38
s_waitcnt vmcnt(11)
s_barrier
buffer_load_dwordx4 v12, s[12:15], s32 offen offset:0 lds
buffer_load_dwordx4 v13, s[12:15], s32 offen offset:1024 lds
buffer_load_dwordx4 v14, s[12:15], s32 offen offset:2048 lds
s_branch L_helper
.p2align 12
L_pre0:
v_lshlrev_b32 v49, 16, v49
v_add_f32 v49, 0x3727c5ac, v49
v_cvt_pk_bf16_f32 v49, v49, v49
v_lshlrev_b32 v49, 16, v49
v_sqrt_f32 v49, v49
v_lshlrev_b32 v50, 16, v50
v_cvt_pk_bf16_f32 v49, v49, v49
v_lshlrev_b32 v49, 16, v49
v_rcp_f32 v49, v49
v_lshlrev_b32 v48, 16, v48
v_cvt_pk_bf16_f32 v49, v49, v49
v_lshlrev_b32 v49, 16, v49
v_mul_f32 v49, v50, v49
v_cvt_pk_bf16_f32 v49, v49, v49
v_lshlrev_b32 v49, 16, v49
v_lshlrev_b32 v51, 16, v51
v_mov_b32 v20, 0xbfb8aa3b
v_mov_b32 v21, 0xbfb8aa3b
v_fma_f32 v51, -v48, v49, v51
v_mul_f32 v49, v20, v49
v_mul_f32 v51, v20, v51
s_branch L_lloop
L_pre1:
v_lshlrev_b32 v7, 1, v1
s_lshl_b32 s39, s26, 1
s_mov_b32 s22, 2048
s_mov_b32 s23, 0x20000
s_mov_b32 s20, s48
s_mov_b32 s21, s49
buffer_load_ushort v48, v7, s[20:23], s39 offen
s_mov_b32 s20, s50
s_mov_b32 s21, s51
buffer_load_ushort v49, v7, s[20:23], s39 offen
s_mov_b32 s20, s52
s_mov_b32 s21, s53
buffer_load_ushort v50, v7, s[20:23], s39 offen
s_mov_b32 s20, s54
s_mov_b32 s21, s55
buffer_load_ushort v51, v7, s[20:23], s39 offen
s_waitcnt vmcnt(15)
s_branch L_lbar
L_helper:
s_waitcnt vmcnt(3)
s_barrier
s_mov_b32 s16, s56
s_mov_b32 s17, s57
s_mov_b32 s18, 8388608
s_mov_b32 s19, 0x20000
s_waitcnt vmcnt(0)
s_barrier
ds_write_b32 v54, v49
ds_write_b32 v54, v51 offset:256
ds_read_b128 v[32:35], v55 offset:0
ds_read_b128 v[40:43], v55 offset:256
ds_read_b128 v[36:39], v55 offset:16
ds_read_b128 v[44:47], v55 offset:272
s_barrier
ds_read_b128 v[48:51], v16 offset:0
ds_read_b128 v[52:55], v17 offset:0
s_waitcnt lgkmcnt(0)
v_fma_f32 v56, v48, v32, v40
v_fma_f32 v57, v49, v33, v41
v_fma_f32 v58, v50, v34, v42
v_fma_f32 v59, v51, v35, v43
v_fma_f32 v60, v52, v36, v44
v_fma_f32 v61, v53, v37, v45
v_fma_f32 v62, v54, v38, v46
v_fma_f32 v63, v55, v39, v47
v_exp_f32 v22, v56
v_exp_f32 v23, v57
v_exp_f32 v24, v58
v_exp_f32 v25, v59
v_exp_f32 v26, v60
v_exp_f32 v27, v61
v_exp_f32 v28, v62
v_exp_f32 v29, v63
v_fma_f32 v22, v22, v20, v20
v_fma_f32 v23, v23, v20, v20
v_fma_f32 v24, v24, v20, v20
v_fma_f32 v25, v25, v20, v20
v_fma_f32 v26, v26, v20, v20
v_fma_f32 v27, v27, v20, v20
v_fma_f32 v28, v28, v20, v20
v_fma_f32 v29, v29, v20, v20
v_rcp_f32 v22, v22
v_rcp_f32 v23, v23
v_rcp_f32 v24, v24
v_rcp_f32 v25, v25
v_rcp_f32 v26, v26
v_rcp_f32 v27, v27
v_rcp_f32 v28, v28
s_barrier
ds_read_b128 v[48:51], v16 offset:8192
ds_read_b128 v[52:55], v17 offset:8192
v_rcp_f32 v29, v29
v_mul_f32 v22, v22, v56
v_mul_f32 v23, v23, v57
v_mul_f32 v24, v24, v58
v_mul_f32 v25, v25, v59
v_mul_f32 v26, v26, v60
v_mul_f32 v27, v27, v61
v_mul_f32 v28, v28, v62
v_mul_f32 v29, v29, v63
v_cvt_pk_bf16_f32 v8, v22, v23
v_cvt_pk_bf16_f32 v9, v24, v25
v_cvt_pk_bf16_f32 v10, v26, v27
v_cvt_pk_bf16_f32 v11, v28, v29
s_xor_b32 s40, s34, 0
buffer_store_dwordx4 v[8:11], v18, s[16:19], s40 offen sc0 sc1
s_waitcnt lgkmcnt(0)
v_fma_f32 v56, v48, v32, v40
v_fma_f32 v57, v49, v33, v41
v_fma_f32 v58, v50, v34, v42
v_fma_f32 v59, v51, v35, v43
v_fma_f32 v60, v52, v36, v44
v_fma_f32 v61, v53, v37, v45
v_fma_f32 v62, v54, v38, v46
v_fma_f32 v63, v55, v39, v47
v_exp_f32 v22, v56
v_exp_f32 v23, v57
v_exp_f32 v24, v58
v_exp_f32 v25, v59
v_exp_f32 v26, v60
v_exp_f32 v27, v61
v_exp_f32 v28, v62
v_exp_f32 v29, v63
v_fma_f32 v22, v22, v20, v20
v_fma_f32 v23, v23, v20, v20
v_fma_f32 v24, v24, v20, v20
v_fma_f32 v25, v25, v20, v20
v_fma_f32 v26, v26, v20, v20
v_fma_f32 v27, v27, v20, v20
v_fma_f32 v28, v28, v20, v20
v_fma_f32 v29, v29, v20, v20
v_rcp_f32 v22, v22
v_rcp_f32 v23, v23
s_barrier
ds_read_b128 v[48:51], v16 offset:16384
ds_read_b128 v[52:55], v17 offset:16384
v_rcp_f32 v24, v24
v_rcp_f32 v25, v25
v_rcp_f32 v26, v26
v_rcp_f32 v27, v27
v_rcp_f32 v28, v28
v_rcp_f32 v29, v29
v_mul_f32 v22, v22, v56
v_mul_f32 v23, v23, v57
v_mul_f32 v24, v24, v58
v_mul_f32 v25, v25, v59
v_mul_f32 v26, v26, v60
v_mul_f32 v27, v27, v61
v_mul_f32 v28, v28, v62
v_mul_f32 v29, v29, v63
v_cvt_pk_bf16_f32 v12, v22, v23
v_cvt_pk_bf16_f32 v13, v24, v25
v_cvt_pk_bf16_f32 v14, v26, v27
v_cvt_pk_bf16_f32 v15, v28, v29
s_xor_b32 s40, s34, 2048
buffer_store_dwordx4 v[12:15], v18, s[16:19], s40 offen sc0 sc1
s_waitcnt lgkmcnt(0)
v_fma_f32 v56, v48, v32, v40
v_fma_f32 v57, v49, v33, v41
v_fma_f32 v58, v50, v34, v42
v_fma_f32 v59, v51, v35, v43
v_fma_f32 v60, v52, v36, v44
v_fma_f32 v61, v53, v37, v45
v_fma_f32 v62, v54, v38, v46
v_fma_f32 v63, v55, v39, v47
v_exp_f32 v22, v56
v_exp_f32 v23, v57
v_exp_f32 v24, v58
v_exp_f32 v25, v59
v_exp_f32 v26, v60
v_exp_f32 v27, v61
v_exp_f32 v28, v62
v_exp_f32 v29, v63
v_fma_f32 v22, v22, v20, v20
v_fma_f32 v23, v23, v20, v20
s_barrier
ds_read_b128 v[48:51], v16 offset:24576
ds_read_b128 v[52:55], v17 offset:24576
v_fma_f32 v24, v24, v20, v20
v_fma_f32 v25, v25, v20, v20
v_fma_f32 v26, v26, v20, v20
v_fma_f32 v27, v27, v20, v20
v_fma_f32 v28, v28, v20, v20
v_fma_f32 v29, v29, v20, v20
v_rcp_f32 v22, v22
v_rcp_f32 v23, v23
v_rcp_f32 v24, v24
v_rcp_f32 v25, v25
v_rcp_f32 v26, v26
v_rcp_f32 v27, v27
v_rcp_f32 v28, v28
v_rcp_f32 v29, v29
v_mul_f32 v22, v22, v56
v_mul_f32 v23, v23, v57
v_mul_f32 v24, v24, v58
v_mul_f32 v25, v25, v59
v_mul_f32 v26, v26, v60
v_mul_f32 v27, v27, v61
v_mul_f32 v28, v28, v62
v_mul_f32 v29, v29, v63
v_cvt_pk_bf16_f32 v8, v22, v23
v_cvt_pk_bf16_f32 v9, v24, v25
v_cvt_pk_bf16_f32 v10, v26, v27
v_cvt_pk_bf16_f32 v11, v28, v29
s_xor_b32 s40, s34, 4096
buffer_store_dwordx4 v[8:11], v18, s[16:19], s40 offen sc0 sc1
s_waitcnt lgkmcnt(0)
v_fma_f32 v56, v48, v32, v40
v_fma_f32 v57, v49, v33, v41
v_fma_f32 v58, v50, v34, v42
v_fma_f32 v59, v51, v35, v43
v_fma_f32 v60, v52, v36, v44
v_fma_f32 v61, v53, v37, v45
v_fma_f32 v62, v54, v38, v46
v_fma_f32 v63, v55, v39, v47
v_exp_f32 v22, v56
v_exp_f32 v23, v57
v_exp_f32 v24, v58
v_exp_f32 v25, v59
s_barrier
ds_read_b128 v[48:51], v16 offset:0
ds_read_b128 v[52:55], v17 offset:0
v_exp_f32 v26, v60
v_exp_f32 v27, v61
v_exp_f32 v28, v62
v_exp_f32 v29, v63
v_fma_f32 v22, v22, v20, v20
v_fma_f32 v23, v23, v20, v20
v_fma_f32 v24, v24, v20, v20
v_fma_f32 v25, v25, v20, v20
v_fma_f32 v26, v26, v20, v20
v_fma_f32 v27, v27, v20, v20
v_fma_f32 v28, v28, v20, v20
v_fma_f32 v29, v29, v20, v20
v_rcp_f32 v22, v22
v_rcp_f32 v23, v23
v_rcp_f32 v24, v24
v_rcp_f32 v25, v25
v_rcp_f32 v26, v26
v_rcp_f32 v27, v27
v_rcp_f32 v28, v28
v_rcp_f32 v29, v29
v_mul_f32 v22, v22, v56
v_mul_f32 v23, v23, v57
v_mul_f32 v24, v24, v58
v_mul_f32 v25, v25, v59
v_mul_f32 v26, v26, v60
v_mul_f32 v27, v27, v61
v_mul_f32 v28, v28, v62
v_mul_f32 v29, v29, v63
v_cvt_pk_bf16_f32 v12, v22, v23
v_cvt_pk_bf16_f32 v13, v24, v25
v_cvt_pk_bf16_f32 v14, v26, v27
v_cvt_pk_bf16_f32 v15, v28, v29
s_xor_b32 s40, s34, 6144
buffer_store_dwordx4 v[12:15], v18, s[16:19], s40 offen sc0 sc1
s_waitcnt lgkmcnt(0)
v_fma_f32 v56, v48, v32, v40
v_fma_f32 v57, v49, v33, v41
v_fma_f32 v58, v50, v34, v42
v_fma_f32 v59, v51, v35, v43
v_fma_f32 v60, v52, v36, v44
v_fma_f32 v61, v53, v37, v45
s_barrier
v_fma_f32 v62, v54, v38, v46
v_fma_f32 v63, v55, v39, v47
ds_read_b128 v[48:51], v16 offset:8192
ds_read_b128 v[52:55], v17 offset:8192
v_exp_f32 v22, v56
v_exp_f32 v23, v57
v_exp_f32 v24, v58
v_exp_f32 v25, v59
v_exp_f32 v26, v60
v_exp_f32 v27, v61
v_exp_f32 v28, v62
v_exp_f32 v29, v63
v_fma_f32 v22, v22, v20, v20
v_fma_f32 v23, v23, v20, v20
v_fma_f32 v24, v24, v20, v20
v_fma_f32 v25, v25, v20, v20
v_fma_f32 v26, v26, v20, v20
v_fma_f32 v27, v27, v20, v20
v_fma_f32 v28, v28, v20, v20
v_fma_f32 v29, v29, v20, v20
v_rcp_f32 v22, v22
v_rcp_f32 v23, v23
v_rcp_f32 v24, v24
v_rcp_f32 v25, v25
v_rcp_f32 v26, v26
v_rcp_f32 v27, v27
v_rcp_f32 v28, v28
v_rcp_f32 v29, v29
v_mul_f32 v22, v22, v56
v_mul_f32 v23, v23, v57
v_mul_f32 v24, v24, v58
v_mul_f32 v25, v25, v59
v_mul_f32 v26, v26, v60
v_mul_f32 v27, v27, v61
v_mul_f32 v28, v28, v62
v_mul_f32 v29, v29, v63
v_cvt_pk_bf16_f32 v8, v22, v23
v_cvt_pk_bf16_f32 v9, v24, v25
v_cvt_pk_bf16_f32 v10, v26, v27
v_cvt_pk_bf16_f32 v11, v28, v29
s_xor_b32 s40, s34, 8192
buffer_store_dwordx4 v[8:11], v18, s[16:19], s40 offen sc0 sc1
s_waitcnt lgkmcnt(0)
v_fma_f32 v56, v48, v32, v40
v_fma_f32 v57, v49, v33, v41
v_fma_f32 v58, v50, v34, v42
v_fma_f32 v59, v51, v35, v43
v_fma_f32 v60, v52, v36, v44
v_fma_f32 v61, v53, v37, v45
v_fma_f32 v62, v54, v38, v46
v_fma_f32 v63, v55, v39, v47
v_exp_f32 v22, v56
v_exp_f32 v23, v57
v_exp_f32 v24, v58
v_exp_f32 v25, v59
v_exp_f32 v26, v60
v_exp_f32 v27, v61
v_exp_f32 v28, v62
v_exp_f32 v29, v63
v_pk_fma_f32 v[22:23], v[22:23], v[20:21], v[20:21]
v_pk_fma_f32 v[24:25], v[24:25], v[20:21], v[20:21]
v_pk_fma_f32 v[26:27], v[26:27], v[20:21], v[20:21]
v_pk_fma_f32 v[28:29], v[28:29], v[20:21], v[20:21]
v_rcp_f32 v22, v22
v_rcp_f32 v23, v23
v_rcp_f32 v24, v24
v_rcp_f32 v25, v25
v_rcp_f32 v26, v26
v_rcp_f32 v27, v27
v_rcp_f32 v28, v28
v_rcp_f32 v29, v29
v_pk_mul_f32 v[22:23], v[22:23], v[56:57]
v_pk_mul_f32 v[24:25], v[24:25], v[58:59]
s_barrier
ds_read_b128 v[48:51], v16 offset:16384
ds_read_b128 v[52:55], v17 offset:16384
v_pk_mul_f32 v[26:27], v[26:27], v[60:61]
v_pk_mul_f32 v[28:29], v[28:29], v[62:63]
v_cvt_pk_bf16_f32 v12, v22, v23
v_cvt_pk_bf16_f32 v13, v24, v25
v_cvt_pk_bf16_f32 v14, v26, v27
v_cvt_pk_bf16_f32 v15, v28, v29
s_xor_b32 s40, s34, 10240
buffer_store_dwordx4 v[12:15], v18, s[16:19], s40 offen sc0 sc1
s_waitcnt lgkmcnt(0)
v_pk_fma_f32 v[56:57], v[48:49], v[32:33], v[40:41]
v_pk_fma_f32 v[58:59], v[50:51], v[34:35], v[42:43]
v_pk_fma_f32 v[60:61], v[52:53], v[36:37], v[44:45]
v_pk_fma_f32 v[62:63], v[54:55], v[38:39], v[46:47]
ds_read_b128 v[48:51], v16 offset:24576
ds_read_b128 v[52:55], v17 offset:24576
v_exp_f32 v22, v56
v_exp_f32 v23, v57
v_exp_f32 v24, v58
v_exp_f32 v25, v59
v_exp_f32 v26, v60
v_exp_f32 v27, v61
v_exp_f32 v28, v62
v_exp_f32 v29, v63
v_pk_fma_f32 v[22:23], v[22:23], v[20:21], v[20:21]
v_pk_fma_f32 v[24:25], v[24:25], v[20:21], v[20:21]
v_pk_fma_f32 v[26:27], v[26:27], v[20:21], v[20:21]
v_pk_fma_f32 v[28:29], v[28:29], v[20:21], v[20:21]
v_rcp_f32 v22, v22
v_rcp_f32 v23, v23
v_rcp_f32 v24, v24
v_rcp_f32 v25, v25
v_rcp_f32 v26, v26
v_rcp_f32 v27, v27
v_rcp_f32 v28, v28
v_rcp_f32 v29, v29
v_pk_mul_f32 v[22:23], v[22:23], v[56:57]
v_pk_mul_f32 v[24:25], v[24:25], v[58:59]
v_pk_mul_f32 v[26:27], v[26:27], v[60:61]
v_pk_mul_f32 v[28:29], v[28:29], v[62:63]
v_cvt_pk_bf16_f32 v8, v22, v23
v_cvt_pk_bf16_f32 v9, v24, v25
v_cvt_pk_bf16_f32 v10, v26, v27
v_cvt_pk_bf16_f32 v11, v28, v29
s_xor_b32 s40, s34, 12288
buffer_store_dwordx4 v[8:11], v18, s[16:19], s40 offen sc0 sc1
s_waitcnt lgkmcnt(0)
v_pk_fma_f32 v[56:57], v[48:49], v[32:33], v[40:41]
v_pk_fma_f32 v[58:59], v[50:51], v[34:35], v[42:43]
v_pk_fma_f32 v[60:61], v[52:53], v[36:37], v[44:45]
v_pk_fma_f32 v[62:63], v[54:55], v[38:39], v[46:47]
v_exp_f32 v22, v56
v_exp_f32 v23, v57
v_exp_f32 v24, v58
v_exp_f32 v25, v59
v_exp_f32 v26, v60
v_exp_f32 v27, v61
v_exp_f32 v28, v62
v_exp_f32 v29, v63
v_pk_fma_f32 v[22:23], v[22:23], v[20:21], v[20:21]
v_pk_fma_f32 v[24:25], v[24:25], v[20:21], v[20:21]
v_pk_fma_f32 v[26:27], v[26:27], v[20:21], v[20:21]
v_pk_fma_f32 v[28:29], v[28:29], v[20:21], v[20:21]
v_rcp_f32 v22, v22
v_rcp_f32 v23, v23
v_rcp_f32 v24, v24
v_rcp_f32 v25, v25
v_rcp_f32 v26, v26
v_rcp_f32 v27, v27
v_rcp_f32 v28, v28
v_rcp_f32 v29, v29
v_pk_mul_f32 v[22:23], v[22:23], v[56:57]
v_pk_mul_f32 v[24:25], v[24:25], v[58:59]
v_pk_mul_f32 v[26:27], v[26:27], v[60:61]
v_pk_mul_f32 v[28:29], v[28:29], v[62:63]
v_cvt_pk_bf16_f32 v12, v22, v23
v_cvt_pk_bf16_f32 v13, v24, v25
v_cvt_pk_bf16_f32 v14, v26, v27
v_cvt_pk_bf16_f32 v15, v28, v29
s_xor_b32 s40, s34, 14336
buffer_store_dwordx4 v[12:15], v18, s[16:19], s40 offen sc0 sc1
L_hdone:
s_endpgm
L_pad:
.fill 390, 4, 0xbf800000
L_compute:
s_setprio 1
s_mov_b32 s33, 1024
v_lshrrev_b32 v2, 4, v1
v_and_b32 v3, 15, v1
s_lshr_b32 s39, s24, 1
s_lshl_b32 s39, s39, 4
s_mul_i32 s41, s7, 9216
s_and_b32 s41, s41, 17408
s_and_b32 s101, s2, 128
s_lshr_b32 s101, s101, 1
s_add_u32 s40, s39, 0
v_add_u32 v4, s40, v3
v_and_b32 v5, 6, v4
v_xor_b32 v5, v5, v2
v_lshlrev_b32 v5, 4, v5
v_xor_b32 v5, s101, v5
v_and_b32 v6, 15, v4
v_lshlrev_b32 v6, 7, v6
v_bfe_u32 v7, v4, 4, 1
v_lshl_add_u32 v6, v7, 14, v6
v_xor_b32 v6, s41, v6
v_or_b32 v16, v6, v5
s_add_u32 s40, s39, -1
v_add_u32 v4, s40, v3
v_and_b32 v5, 6, v4
v_xor_b32 v5, v5, v2
v_lshlrev_b32 v5, 4, v5
v_xor_b32 v5, s101, v5
v_and_b32 v6, 15, v4
v_lshlrev_b32 v6, 7, v6
v_bfe_u32 v7, v4, 4, 1
v_lshl_add_u32 v6, v7, 14, v6
v_xor_b32 v6, s41, v6
v_add_u32 v6, 14336, v6
v_cmp_gt_u32 vcc, 32, v4
v_mov_b32 v7, 98432
v_mov_b32 v19, 0xf00
v_mov_b32 v4, 0x18000
v_cndmask_b32 v6, v7, v6, vcc
v_cndmask_b32 v19, v19, v4, vcc
v_or_b32 v17, v6, v5
s_add_u32 s40, s39, 1
v_add_u32 v4, s40, v3
v_and_b32 v5, 6, v4
v_xor_b32 v5, v5, v2
v_lshlrev_b32 v5, 4, v5
v_xor_b32 v5, s101, v5
v_and_b32 v6, 15, v4
v_lshlrev_b32 v6, 7, v6
v_bfe_u32 v7, v4, 4, 1
v_lshl_add_u32 v6, v7, 14, v6
v_xor_b32 v6, s41, v6
v_cmp_gt_u32 vcc, 32, v4
v_mov_b32 v7, 98304
v_mov_b32 v20, 0xf00
v_mov_b32 v4, 0x18000
v_cndmask_b32 v6, v7, v6, vcc
v_cndmask_b32 v20, v20, v4, vcc
v_or_b32 v18, v6, v5
v_and_b32 v4, 1, v2
v_lshlrev_b32 v4, 1, v4
v_bfe_u32 v5, v3, 3, 1
v_or_b32 v4, v4, v5
s_and_b32 s40, s24, 1
s_lshl_b32 s41, s40, 1
v_xor_b32 v4, s41, v4
v_lshlrev_b32 v4, 5, v4
v_and_b32 v5, 3, v3
v_lshl_add_u32 v4, v5, 3, v4
v_lshrrev_b32 v5, 2, v3
v_lshl_add_u32 v4, v5, 7, v4
v_mul_u32_u24 v5, 3072, v2
v_add_u32 v24, v4, v5
v_xor_b32 v25, 32, v24
s_add_u32 s41, s33, 0xf00
s_and_b32 s41, s41, 0xf00
v_mov_b32 v8, v16
v_and_or_b32 v9, s41, v19, v17
v_and_or_b32 v10, s41, v20, v18
v_xor_b32 v11, 64, v8
v_xor_b32 v12, 64, v9
v_xor_b32 v13, 64, v10
v_add_u32 v14, 102400, v24
v_add_u32 v15, 102400, v25
v_lshl_or_b32 v4, s40, 3, v2
v_and_b32 v5, 7, v3
v_xor_b32 v4, v4, v5
v_lshlrev_b32 v4, 4, v4
v_add_u32 v5, s39, v3
v_lshl_add_u32 v4, v5, 8, v4
v_add_u32 v28, 32768, v4
v_xor_b32 v29, 64, v28
s_mov_b32 s28, 0
s_mov_b32 s30, 102400
s_mov_b32 s34, s33
s_mov_b32 s27, 2
v_or_b32 v21, s28, v16
v_and_or_b32 v22, s34, v19, v17
v_and_or_b32 v23, s34, v20, v18
v_add_u32 v26, s30, v24
v_add_u32 v27, s30, v25
s_and_b32 s39, s26, 448
s_cmp_eq_u32 s39, 192
s_cselect_b32 s101, 0, s101
v_xor_b32 v21, s101, v21
v_xor_b32 v22, s101, v22
v_xor_b32 v23, s101, v23
s_add_u32 s30, s30, 12288
s_cmp_eq_u32 s30, 163840
s_cselect_b32 s30, 102400, s30
s_waitcnt vmcnt(0)
s_cmp_eq_u32 0, 0
s_branch L_touch
L_ret:
s_waitcnt lgkmcnt(0)
s_barrier
ds_read_b64_tr_b16 v[104:105], v26 offset:0
ds_read_b64_tr_b16 v[106:107], v26 offset:512
ds_read_b128 v[64:67], v22
ds_read_b64_tr_b16 v[112:113], v26 offset:1024
ds_read_b64_tr_b16 v[114:115], v26 offset:1536
ds_read_b128 v[68:71], v21 offset:0
ds_read_b64_tr_b16 v[120:121], v26 offset:2048
ds_read_b64_tr_b16 v[122:123], v26 offset:2560
ds_read_b128 v[72:75], v21 offset:2048
ds_read_b128 v[76:79], v21 offset:4096
s_waitcnt lgkmcnt(7)
v_mfma_f32_16x16x32_bf16 a[0:3], v[104:107], v[64:67], 0
ds_read_b128 v[80:83], v21 offset:6144
v_add_u32 v26, s30, v24
s_waitcnt lgkmcnt(5)
v_mfma_f32_16x16x32_bf16 a[0:3], v[112:115], v[68:71], a[0:3]
ds_read_b128 v[84:87], v21 offset:8192
s_waitcnt lgkmcnt(3)
v_mfma_f32_16x16x32_bf16 a[0:3], v[120:123], v[72:75], a[0:3]
ds_read_b128 v[88:91], v21 offset:10240
s_waitcnt lgkmcnt(3)
v_mfma_f32_16x16x32_bf16 a[8:11], v[120:123], v[76:79], 0
ds_read_b128 v[92:95], v21 offset:12288
v_mfma_f32_16x16x32_bf16 a[8:11], v[112:115], v[72:75], a[8:11]
ds_read_b128 v[96:99], v21 offset:14336
v_mfma_f32_16x16x32_bf16 a[8:11], v[104:107], v[68:71], a[8:11]
ds_read_b128 v[100:103], v23
v_mfma_f32_16x16x32_bf16 a[16:19], v[104:107], v[72:75], 0
ds_read_b64_tr_b16 v[108:109], v27 offset:0
v_mfma_f32_16x16x32_bf16 a[16:19], v[112:115], v[76:79], a[16:19]
ds_read_b64_tr_b16 v[110:111], v27 offset:512
v_xor_b32 v21, 64, v21
s_waitcnt lgkmcnt(7)
v_mfma_f32_16x16x32_bf16 a[16:19], v[120:123], v[80:83], a[16:19]
ds_read_b64_tr_b16 v[116:117], v27 offset:1024
v_xor_b32 v22, 64, v22
s_waitcnt lgkmcnt(7)
v_mfma_f32_16x16x32_bf16 a[24:27], v[120:123], v[84:87], 0
ds_read_b64_tr_b16 v[118:119], v27 offset:1536
v_xor_b32 v23, 64, v23
v_mfma_f32_16x16x32_bf16 a[24:27], v[112:115], v[80:83], a[24:27]
ds_read_b64_tr_b16 v[124:125], v27 offset:2048
v_mfma_f32_16x16x32_bf16 a[24:27], v[104:107], v[76:79], a[24:27]
ds_read_b64_tr_b16 v[126:127], v27 offset:2560
v_add_u32 v27, s30, v25
v_mfma_f32_16x16x32_bf16 a[32:35], v[104:107], v[80:83], 0
ds_read_b128 v[128:131], v22
v_mfma_f32_16x16x32_bf16 a[32:35], v[112:115], v[84:87], a[32:35]
ds_read_b128 v[132:135], v21 offset:0
s_waitcnt lgkmcnt(11)
v_mfma_f32_16x16x32_bf16 a[32:35], v[120:123], v[88:91], a[32:35]
ds_read_b128 v[136:139], v21 offset:2048
s_waitcnt lgkmcnt(11)
v_mfma_f32_16x16x32_bf16 a[40:43], v[120:123], v[92:95], 0
ds_read_b128 v[140:143], v21 offset:4096
v_mfma_f32_16x16x32_bf16 a[40:43], v[112:115], v[88:91], a[40:43]
ds_read_b128 v[144:147], v21 offset:6144
v_mfma_f32_16x16x32_bf16 a[40:43], v[104:107], v[84:87], a[40:43]
ds_read_b128 v[148:151], v21 offset:8192
v_mfma_f32_16x16x32_bf16 a[48:51], v[104:107], v[88:91], 0
ds_read_b128 v[152:155], v21 offset:10240
v_mfma_f32_16x16x32_bf16 a[48:51], v[112:115], v[92:95], a[48:51]
ds_read_b128 v[156:159], v21 offset:12288
s_waitcnt lgkmcnt(14)
v_mfma_f32_16x16x32_bf16 a[48:51], v[120:123], v[96:99], a[48:51]
ds_read_b128 v[160:163], v21 offset:14336
v_mfma_f32_16x16x32_bf16 a[56:59], v[120:123], v[100:103], 0
ds_read_b128 v[164:167], v23
v_mfma_f32_16x16x32_bf16 a[56:59], v[112:115], v[96:99], a[56:59]
s_add_u32 s28, s28, 32768
s_cmp_eq_u32 s28, 98304
s_cselect_b32 s28, 0, s28
v_mfma_f32_16x16x32_bf16 a[56:59], v[104:107], v[92:95], a[56:59]
s_add_u32 s30, s30, 12288
s_cmp_eq_u32 s30, 163840
s_cselect_b32 s30, 102400, s30
s_waitcnt lgkmcnt(14)
v_mfma_f32_16x16x32_bf16 a[60:63], v[108:111], v[92:95], 0
s_add_u32 s33, s33, 256
s_and_b32 s33, s33, 0xf00
s_or_b32 s34, s28, s33
s_waitcnt lgkmcnt(12)
v_mfma_f32_16x16x32_bf16 a[60:63], v[116:119], v[96:99], a[60:63]
v_or_b32 v21, s28, v16
s_waitcnt lgkmcnt(10)
v_mfma_f32_16x16x32_bf16 a[60:63], v[124:127], v[100:103], a[60:63]
v_and_or_b32 v22, s34, v19, v17
v_mfma_f32_16x16x32_bf16 a[52:55], v[124:127], v[96:99], 0
v_and_or_b32 v23, s34, v20, v18
v_mfma_f32_16x16x32_bf16 a[52:55], v[116:119], v[92:95], a[52:55]
v_mfma_f32_16x16x32_bf16 a[52:55], v[108:111], v[88:91], a[52:55]
v_mfma_f32_16x16x32_bf16 a[44:47], v[108:111], v[84:87], 0
v_mfma_f32_16x16x32_bf16 a[44:47], v[116:119], v[88:91], a[44:47]
v_mfma_f32_16x16x32_bf16 a[44:47], v[124:127], v[92:95], a[44:47]
v_mfma_f32_16x16x32_bf16 a[36:39], v[124:127], v[88:91], 0
v_mfma_f32_16x16x32_bf16 a[36:39], v[116:119], v[84:87], a[36:39]
v_mfma_f32_16x16x32_bf16 a[36:39], v[108:111], v[80:83], a[36:39]
v_mfma_f32_16x16x32_bf16 a[28:31], v[108:111], v[76:79], 0
v_mfma_f32_16x16x32_bf16 a[28:31], v[116:119], v[80:83], a[28:31]
v_mfma_f32_16x16x32_bf16 a[28:31], v[124:127], v[84:87], a[28:31]
v_mfma_f32_16x16x32_bf16 a[20:23], v[124:127], v[80:83], 0
s_barrier
v_mfma_f32_16x16x32_bf16 a[20:23], v[116:119], v[76:79], a[20:23]
ds_read_b64_tr_b16 v[168:169], v26 offset:0
v_mfma_f32_16x16x32_bf16 a[20:23], v[108:111], v[72:75], a[20:23]
ds_read_b64_tr_b16 v[170:171], v26 offset:512
v_mfma_f32_16x16x32_bf16 a[12:15], v[108:111], v[68:71], 0
ds_read_b64_tr_b16 v[176:177], v26 offset:1024
v_mfma_f32_16x16x32_bf16 a[12:15], v[116:119], v[72:75], a[12:15]
ds_read_b64_tr_b16 v[178:179], v26 offset:1536
v_mfma_f32_16x16x32_bf16 a[12:15], v[124:127], v[76:79], a[12:15]
ds_read_b64_tr_b16 v[184:185], v26 offset:2048
v_mfma_f32_16x16x32_bf16 a[4:7], v[124:127], v[72:75], 0
ds_read_b64_tr_b16 v[186:187], v26 offset:2560
v_mfma_f32_16x16x32_bf16 a[4:7], v[116:119], v[68:71], a[4:7]
ds_read_b64_tr_b16 v[172:173], v27 offset:0
v_add_u32 v26, s30, v24
v_mfma_f32_16x16x32_bf16 a[4:7], v[108:111], v[64:67], a[4:7]
ds_read_b64_tr_b16 v[174:175], v27 offset:512
s_waitcnt lgkmcnt(6)
v_mfma_f32_16x16x32_bf16 a[0:3], v[168:171], v[128:131], a[0:3]
ds_read_b64_tr_b16 v[180:181], v27 offset:1024
s_waitcnt lgkmcnt(5)
v_mfma_f32_16x16x32_bf16 a[0:3], v[176:179], v[132:135], a[0:3]
ds_read_b64_tr_b16 v[182:183], v27 offset:1536
s_waitcnt lgkmcnt(4)
v_mfma_f32_16x16x32_bf16 a[0:3], v[184:187], v[136:139], a[0:3]
ds_read_b64_tr_b16 v[188:189], v27 offset:2048
v_mfma_f32_16x16x32_bf16 a[8:11], v[184:187], v[140:143], a[8:11]
ds_read_b64_tr_b16 v[190:191], v27 offset:2560
v_add_u32 v27, s30, v25
v_mfma_f32_16x16x32_bf16 a[8:11], v[176:179], v[136:139], a[8:11]
v_mfma_f32_16x16x32_bf16 a[8:11], v[168:171], v[132:135], a[8:11]
v_mfma_f32_16x16x32_bf16 a[16:19], v[168:171], v[136:139], a[16:19]
v_mfma_f32_16x16x32_bf16 a[16:19], v[176:179], v[140:143], a[16:19]
v_mfma_f32_16x16x32_bf16 a[16:19], v[184:187], v[144:147], a[16:19]
v_mfma_f32_16x16x32_bf16 a[24:27], v[184:187], v[148:151], a[24:27]
v_mfma_f32_16x16x32_bf16 a[24:27], v[176:179], v[144:147], a[24:27]
v_mfma_f32_16x16x32_bf16 a[24:27], v[168:171], v[140:143], a[24:27]
v_mfma_f32_16x16x32_bf16 a[32:35], v[168:171], v[144:147], a[32:35]
v_mfma_f32_16x16x32_bf16 a[32:35], v[176:179], v[148:151], a[32:35]
v_mfma_f32_16x16x32_bf16 a[32:35], v[184:187], v[152:155], a[32:35]
v_mfma_f32_16x16x32_bf16 a[40:43], v[184:187], v[156:159], a[40:43]
v_mfma_f32_16x16x32_bf16 a[40:43], v[176:179], v[152:155], a[40:43]
v_mfma_f32_16x16x32_bf16 a[40:43], v[168:171], v[148:151], a[40:43]
v_mfma_f32_16x16x32_bf16 a[48:51], v[168:171], v[152:155], a[48:51]
v_mfma_f32_16x16x32_bf16 a[48:51], v[176:179], v[156:159], a[48:51]
v_mfma_f32_16x16x32_bf16 a[48:51], v[184:187], v[160:163], a[48:51]
s_waitcnt lgkmcnt(0)
v_mfma_f32_16x16x32_bf16 a[56:59], v[184:187], v[164:167], a[56:59]
v_mfma_f32_16x16x32_bf16 a[56:59], v[176:179], v[160:163], a[56:59]
s_add_u32 s30, s30, 12288
s_cmp_eq_u32 s30, 163840
s_cselect_b32 s30, 102400, s30
v_mfma_f32_16x16x32_bf16 a[56:59], v[168:171], v[156:159], a[56:59]
v_mfma_f32_16x16x32_bf16 a[60:63], v[172:175], v[156:159], a[60:63]
v_mfma_f32_16x16x32_bf16 a[60:63], v[180:183], v[160:163], a[60:63]
v_mfma_f32_16x16x32_bf16 a[60:63], v[188:191], v[164:167], a[60:63]
v_mfma_f32_16x16x32_bf16 a[52:55], v[188:191], v[160:163], a[52:55]
v_mfma_f32_16x16x32_bf16 a[52:55], v[180:183], v[156:159], a[52:55]
v_mfma_f32_16x16x32_bf16 a[52:55], v[172:175], v[152:155], a[52:55]
v_mfma_f32_16x16x32_bf16 a[44:47], v[172:175], v[148:151], a[44:47]
v_mfma_f32_16x16x32_bf16 a[44:47], v[180:183], v[152:155], a[44:47]
v_mfma_f32_16x16x32_bf16 a[44:47], v[188:191], v[156:159], a[44:47]
v_mfma_f32_16x16x32_bf16 a[36:39], v[188:191], v[152:155], a[36:39]
v_mfma_f32_16x16x32_bf16 a[36:39], v[180:183], v[148:151], a[36:39]
v_mfma_f32_16x16x32_bf16 a[36:39], v[172:175], v[144:147], a[36:39]
v_mfma_f32_16x16x32_bf16 a[28:31], v[172:175], v[140:143], a[28:31]
s_barrier
v_mfma_f32_16x16x32_bf16 a[28:31], v[180:183], v[144:147], a[28:31]
ds_read_b64_tr_b16 v[104:105], v26 offset:0
v_mfma_f32_16x16x32_bf16 a[28:31], v[188:191], v[148:151], a[28:31]
ds_read_b64_tr_b16 v[106:107], v26 offset:512
v_mfma_f32_16x16x32_bf16 a[20:23], v[188:191], v[144:147], a[20:23]
ds_read_b128 v[64:67], v22
v_mfma_f32_16x16x32_bf16 a[20:23], v[180:183], v[140:143], a[20:23]
ds_read_b64_tr_b16 v[112:113], v26 offset:1024
v_xor_b32 v22, 64, v22
v_mfma_f32_16x16x32_bf16 a[20:23], v[172:175], v[136:139], a[20:23]
ds_read_b64_tr_b16 v[114:115], v26 offset:1536
v_mfma_f32_16x16x32_bf16 a[12:15], v[172:175], v[132:135], a[12:15]
ds_read_b128 v[68:71], v21 offset:0
v_mfma_f32_16x16x32_bf16 a[12:15], v[180:183], v[136:139], a[12:15]
ds_read_b64_tr_b16 v[120:121], v26 offset:2048
v_mfma_f32_16x16x32_bf16 a[12:15], v[188:191], v[140:143], a[12:15]
ds_read_b64_tr_b16 v[122:123], v26 offset:2560
v_mfma_f32_16x16x32_bf16 a[4:7], v[188:191], v[136:139], a[4:7]
ds_read_b128 v[72:75], v21 offset:2048
v_add_u32 v26, s30, v24
v_mfma_f32_16x16x32_bf16 a[4:7], v[180:183], v[132:135], a[4:7]
ds_read_b128 v[76:79], v21 offset:4096
v_mfma_f32_16x16x32_bf16 a[4:7], v[172:175], v[128:131], a[4:7]
ds_read_b128 v[80:83], v21 offset:6144
s_waitcnt lgkmcnt(8)
v_mfma_f32_16x16x32_bf16 a[0:3], v[104:107], v[64:67], a[0:3]
ds_read_b128 v[84:87], v21 offset:8192
s_waitcnt lgkmcnt(6)
v_mfma_f32_16x16x32_bf16 a[0:3], v[112:115], v[68:71], a[0:3]
ds_read_b128 v[88:91], v21 offset:10240
s_waitcnt lgkmcnt(4)
v_mfma_f32_16x16x32_bf16 a[0:3], v[120:123], v[72:75], a[0:3]
ds_read_b128 v[92:95], v21 offset:12288
s_waitcnt lgkmcnt(4)
v_mfma_f32_16x16x32_bf16 a[8:11], v[120:123], v[76:79], a[8:11]
ds_read_b128 v[96:99], v21 offset:14336
v_mfma_f32_16x16x32_bf16 a[8:11], v[112:115], v[72:75], a[8:11]
ds_read_b128 v[100:103], v23
v_xor_b32 v21, 64, v21
v_mfma_f32_16x16x32_bf16 a[8:11], v[104:107], v[68:71], a[8:11]
ds_read_b64_tr_b16 v[108:109], v27 offset:0
v_xor_b32 v23, 64, v23
v_mfma_f32_16x16x32_bf16 a[16:19], v[104:107], v[72:75], a[16:19]
ds_read_b64_tr_b16 v[110:111], v27 offset:512
v_mfma_f32_16x16x32_bf16 a[16:19], v[112:115], v[76:79], a[16:19]
ds_read_b64_tr_b16 v[116:117], v27 offset:1024
s_waitcnt lgkmcnt(8)
v_mfma_f32_16x16x32_bf16 a[16:19], v[120:123], v[80:83], a[16:19]
ds_read_b64_tr_b16 v[118:119], v27 offset:1536
s_waitcnt lgkmcnt(8)
v_mfma_f32_16x16x32_bf16 a[24:27], v[120:123], v[84:87], a[24:27]
ds_read_b64_tr_b16 v[124:125], v27 offset:2048
v_mfma_f32_16x16x32_bf16 a[24:27], v[112:115], v[80:83], a[24:27]
ds_read_b64_tr_b16 v[126:127], v27 offset:2560
v_add_u32 v27, s30, v25
v_mfma_f32_16x16x32_bf16 a[24:27], v[104:107], v[76:79], a[24:27]
ds_read_b128 v[128:131], v22
v_mfma_f32_16x16x32_bf16 a[32:35], v[104:107], v[80:83], a[32:35]
ds_read_b128 v[132:135], v21 offset:0
v_mfma_f32_16x16x32_bf16 a[32:35], v[112:115], v[84:87], a[32:35]
ds_read_b128 v[136:139], v21 offset:2048
s_waitcnt lgkmcnt(12)
v_mfma_f32_16x16x32_bf16 a[32:35], v[120:123], v[88:91], a[32:35]
ds_read_b128 v[140:143], v21 offset:4096
s_waitcnt lgkmcnt(12)
v_mfma_f32_16x16x32_bf16 a[40:43], v[120:123], v[92:95], a[40:43]
ds_read_b128 v[144:147], v21 offset:6144
v_mfma_f32_16x16x32_bf16 a[40:43], v[112:115], v[88:91], a[40:43]
ds_read_b128 v[148:151], v21 offset:8192
v_mfma_f32_16x16x32_bf16 a[40:43], v[104:107], v[84:87], a[40:43]
ds_read_b128 v[152:155], v21 offset:10240
v_mfma_f32_16x16x32_bf16 a[48:51], v[104:107], v[88:91], a[48:51]
ds_read_b128 v[156:159], v21 offset:12288
v_mfma_f32_16x16x32_bf16 a[48:51], v[112:115], v[92:95], a[48:51]
ds_read_b128 v[160:163], v21 offset:14336
s_waitcnt lgkmcnt(14)
v_mfma_f32_16x16x32_bf16 a[48:51], v[120:123], v[96:99], a[48:51]
ds_read_b128 v[164:167], v23
v_mfma_f32_16x16x32_bf16 a[56:59], v[120:123], v[100:103], a[56:59]
s_add_u32 s28, s28, 32768
s_cmp_eq_u32 s28, 98304
s_cselect_b32 s28, 0, s28
v_mfma_f32_16x16x32_bf16 a[56:59], v[112:115], v[96:99], a[56:59]
s_add_u32 s30, s30, 12288
s_cmp_eq_u32 s30, 163840
s_cselect_b32 s30, 102400, s30
v_mfma_f32_16x16x32_bf16 a[56:59], v[104:107], v[92:95], a[56:59]
s_add_u32 s33, s33, 256
s_and_b32 s33, s33, 0xf00
s_or_b32 s34, s28, s33
s_waitcnt lgkmcnt(14)
v_mfma_f32_16x16x32_bf16 a[60:63], v[108:111], v[92:95], a[60:63]
v_or_b32 v21, s28, v16
s_waitcnt lgkmcnt(12)
v_mfma_f32_16x16x32_bf16 a[60:63], v[116:119], v[96:99], a[60:63]
v_and_or_b32 v22, s34, v19, v17
s_waitcnt lgkmcnt(10)
v_mfma_f32_16x16x32_bf16 a[60:63], v[124:127], v[100:103], a[60:63]
v_and_or_b32 v23, s34, v20, v18
v_mfma_f32_16x16x32_bf16 a[52:55], v[124:127], v[96:99], a[52:55]
v_mfma_f32_16x16x32_bf16 a[52:55], v[116:119], v[92:95], a[52:55]
v_mfma_f32_16x16x32_bf16 a[52:55], v[108:111], v[88:91], a[52:55]
s_barrier
v_mfma_f32_16x16x32_bf16 a[44:47], v[108:111], v[84:87], a[44:47]
ds_read_b64_tr_b16 v[168:169], v26 offset:0
v_mfma_f32_16x16x32_bf16 a[44:47], v[116:119], v[88:91], a[44:47]
ds_read_b64_tr_b16 v[170:171], v26 offset:512
v_mfma_f32_16x16x32_bf16 a[44:47], v[124:127], v[92:95], a[44:47]
ds_read_b64_tr_b16 v[176:177], v26 offset:1024
v_mfma_f32_16x16x32_bf16 a[36:39], v[124:127], v[88:91], a[36:39]
ds_read_b64_tr_b16 v[178:179], v26 offset:1536
v_mfma_f32_16x16x32_bf16 a[36:39], v[116:119], v[84:87], a[36:39]
ds_read_b64_tr_b16 v[184:185], v26 offset:2048
v_mfma_f32_16x16x32_bf16 a[36:39], v[108:111], v[80:83], a[36:39]
ds_read_b64_tr_b16 v[186:187], v26 offset:2560
v_mfma_f32_16x16x32_bf16 a[28:31], v[108:111], v[76:79], a[28:31]
ds_read_b64_tr_b16 v[172:173], v27 offset:0
v_add_u32 v26, s30, v24
v_mfma_f32_16x16x32_bf16 a[28:31], v[116:119], v[80:83], a[28:31]
ds_read_b64_tr_b16 v[174:175], v27 offset:512
v_mfma_f32_16x16x32_bf16 a[28:31], v[124:127], v[84:87], a[28:31]
ds_read_b64_tr_b16 v[180:181], v27 offset:1024
v_mfma_f32_16x16x32_bf16 a[20:23], v[124:127], v[80:83], a[20:23]
ds_read_b64_tr_b16 v[182:183], v27 offset:1536
v_mfma_f32_16x16x32_bf16 a[20:23], v[116:119], v[76:79], a[20:23]
ds_read_b64_tr_b16 v[188:189], v27 offset:2048
v_mfma_f32_16x16x32_bf16 a[20:23], v[108:111], v[72:75], a[20:23]
ds_read_b64_tr_b16 v[190:191], v27 offset:2560
v_add_u32 v27, s30, v25
v_mfma_f32_16x16x32_bf16 a[12:15], v[108:111], v[68:71], a[12:15]
v_mfma_f32_16x16x32_bf16 a[12:15], v[116:119], v[72:75], a[12:15]
v_mfma_f32_16x16x32_bf16 a[12:15], v[124:127], v[76:79], a[12:15]
v_mfma_f32_16x16x32_bf16 a[4:7], v[124:127], v[72:75], a[4:7]
v_mfma_f32_16x16x32_bf16 a[4:7], v[116:119], v[68:71], a[4:7]
v_mfma_f32_16x16x32_bf16 a[4:7], v[108:111], v[64:67], a[4:7]
s_waitcnt lgkmcnt(0)
L_loop:
v_mfma_f32_16x16x32_bf16 a[0:3], v[168:171], v[128:131], a[0:3]
v_mfma_f32_16x16x32_bf16 a[0:3], v[176:179], v[132:135], a[0:3]
v_mfma_f32_16x16x32_bf16 a[0:3], v[184:187], v[136:139], a[0:3]
s_add_u32 s30, s30, 12288
s_cmp_eq_u32 s30, 163840
s_cselect_b32 s30, 102400, s30
v_mfma_f32_16x16x32_bf16 a[8:11], v[184:187], v[140:143], a[8:11]
v_mfma_f32_16x16x32_bf16 a[8:11], v[176:179], v[136:139], a[8:11]
v_mfma_f32_16x16x32_bf16 a[8:11], v[168:171], v[132:135], a[8:11]
v_mfma_f32_16x16x32_bf16 a[16:19], v[168:171], v[136:139], a[16:19]
v_mfma_f32_16x16x32_bf16 a[16:19], v[176:179], v[140:143], a[16:19]
v_mfma_f32_16x16x32_bf16 a[16:19], v[184:187], v[144:147], a[16:19]
v_mfma_f32_16x16x32_bf16 a[24:27], v[184:187], v[148:151], a[24:27]
v_mfma_f32_16x16x32_bf16 a[24:27], v[176:179], v[144:147], a[24:27]
v_mfma_f32_16x16x32_bf16 a[24:27], v[168:171], v[140:143], a[24:27]
v_mfma_f32_16x16x32_bf16 a[32:35], v[168:171], v[144:147], a[32:35]
v_mfma_f32_16x16x32_bf16 a[32:35], v[176:179], v[148:151], a[32:35]
v_mfma_f32_16x16x32_bf16 a[32:35], v[184:187], v[152:155], a[32:35]
v_mfma_f32_16x16x32_bf16 a[40:43], v[184:187], v[156:159], a[40:43]
v_mfma_f32_16x16x32_bf16 a[40:43], v[176:179], v[152:155], a[40:43]
v_mfma_f32_16x16x32_bf16 a[40:43], v[168:171], v[148:151], a[40:43]
v_mfma_f32_16x16x32_bf16 a[48:51], v[168:171], v[152:155], a[48:51]
v_mfma_f32_16x16x32_bf16 a[48:51], v[176:179], v[156:159], a[48:51]
v_mfma_f32_16x16x32_bf16 a[48:51], v[184:187], v[160:163], a[48:51]
v_mfma_f32_16x16x32_bf16 a[56:59], v[184:187], v[164:167], a[56:59]
v_mfma_f32_16x16x32_bf16 a[56:59], v[176:179], v[160:163], a[56:59]
v_mfma_f32_16x16x32_bf16 a[56:59], v[168:171], v[156:159], a[56:59]
v_mfma_f32_16x16x32_bf16 a[60:63], v[172:175], v[156:159], a[60:63]
v_mfma_f32_16x16x32_bf16 a[60:63], v[180:183], v[160:163], a[60:63]
v_mfma_f32_16x16x32_bf16 a[60:63], v[188:191], v[164:167], a[60:63]
v_mfma_f32_16x16x32_bf16 a[52:55], v[188:191], v[160:163], a[52:55]
v_mfma_f32_16x16x32_bf16 a[52:55], v[180:183], v[156:159], a[52:55]
v_mfma_f32_16x16x32_bf16 a[52:55], v[172:175], v[152:155], a[52:55]
v_mfma_f32_16x16x32_bf16 a[44:47], v[172:175], v[148:151], a[44:47]
v_mfma_f32_16x16x32_bf16 a[44:47], v[180:183], v[152:155], a[44:47]
v_mfma_f32_16x16x32_bf16 a[44:47], v[188:191], v[156:159], a[44:47]
v_mfma_f32_16x16x32_bf16 a[36:39], v[188:191], v[152:155], a[36:39]
v_mfma_f32_16x16x32_bf16 a[36:39], v[180:183], v[148:151], a[36:39]
v_mfma_f32_16x16x32_bf16 a[36:39], v[172:175], v[144:147], a[36:39]
v_mfma_f32_16x16x32_bf16 a[28:31], v[172:175], v[140:143], a[28:31]
s_barrier
v_mfma_f32_16x16x32_bf16 a[28:31], v[180:183], v[144:147], a[28:31]
ds_read_b64_tr_b16 v[104:105], v26 offset:0
v_mfma_f32_16x16x32_bf16 a[28:31], v[188:191], v[148:151], a[28:31]
ds_read_b64_tr_b16 v[106:107], v26 offset:512
v_mfma_f32_16x16x32_bf16 a[20:23], v[188:191], v[144:147], a[20:23]
ds_read_b128 v[64:67], v22
v_mfma_f32_16x16x32_bf16 a[20:23], v[180:183], v[140:143], a[20:23]
ds_read_b64_tr_b16 v[112:113], v26 offset:1024
v_xor_b32 v22, 64, v22
v_mfma_f32_16x16x32_bf16 a[20:23], v[172:175], v[136:139], a[20:23]
ds_read_b64_tr_b16 v[114:115], v26 offset:1536
v_mfma_f32_16x16x32_bf16 a[12:15], v[172:175], v[132:135], a[12:15]
ds_read_b128 v[68:71], v21 offset:0
v_mfma_f32_16x16x32_bf16 a[12:15], v[180:183], v[136:139], a[12:15]
ds_read_b64_tr_b16 v[120:121], v26 offset:2048
v_mfma_f32_16x16x32_bf16 a[12:15], v[188:191], v[140:143], a[12:15]
ds_read_b64_tr_b16 v[122:123], v26 offset:2560
v_mfma_f32_16x16x32_bf16 a[4:7], v[188:191], v[136:139], a[4:7]
ds_read_b128 v[72:75], v21 offset:2048
v_add_u32 v26, s30, v24
v_mfma_f32_16x16x32_bf16 a[4:7], v[180:183], v[132:135], a[4:7]
ds_read_b128 v[76:79], v21 offset:4096
v_mfma_f32_16x16x32_bf16 a[4:7], v[172:175], v[128:131], a[4:7]
ds_read_b128 v[80:83], v21 offset:6144
s_waitcnt lgkmcnt(8)
v_mfma_f32_16x16x32_bf16 a[0:3], v[104:107], v[64:67], a[0:3]
ds_read_b128 v[84:87], v21 offset:8192
s_waitcnt lgkmcnt(6)
v_mfma_f32_16x16x32_bf16 a[0:3], v[112:115], v[68:71], a[0:3]
ds_read_b128 v[88:91], v21 offset:10240
s_waitcnt lgkmcnt(4)
v_mfma_f32_16x16x32_bf16 a[0:3], v[120:123], v[72:75], a[0:3]
ds_read_b128 v[92:95], v21 offset:12288
s_waitcnt lgkmcnt(4)
v_mfma_f32_16x16x32_bf16 a[8:11], v[120:123], v[76:79], a[8:11]
ds_read_b128 v[96:99], v21 offset:14336
v_mfma_f32_16x16x32_bf16 a[8:11], v[112:115], v[72:75], a[8:11]
ds_read_b128 v[100:103], v23
v_xor_b32 v21, 64, v21
v_mfma_f32_16x16x32_bf16 a[8:11], v[104:107], v[68:71], a[8:11]
ds_read_b64_tr_b16 v[108:109], v27 offset:0
v_xor_b32 v23, 64, v23
v_mfma_f32_16x16x32_bf16 a[16:19], v[104:107], v[72:75], a[16:19]
ds_read_b64_tr_b16 v[110:111], v27 offset:512
v_mfma_f32_16x16x32_bf16 a[16:19], v[112:115], v[76:79], a[16:19]
ds_read_b64_tr_b16 v[116:117], v27 offset:1024
s_waitcnt lgkmcnt(8)
v_mfma_f32_16x16x32_bf16 a[16:19], v[120:123], v[80:83], a[16:19]
ds_read_b64_tr_b16 v[118:119], v27 offset:1536
s_waitcnt lgkmcnt(8)
v_mfma_f32_16x16x32_bf16 a[24:27], v[120:123], v[84:87], a[24:27]
ds_read_b64_tr_b16 v[124:125], v27 offset:2048
v_mfma_f32_16x16x32_bf16 a[24:27], v[112:115], v[80:83], a[24:27]
ds_read_b64_tr_b16 v[126:127], v27 offset:2560
v_add_u32 v27, s30, v25
v_mfma_f32_16x16x32_bf16 a[24:27], v[104:107], v[76:79], a[24:27]
ds_read_b64_tr_b16 v[168:169], v26 offset:0
v_mfma_f32_16x16x32_bf16 a[32:35], v[104:107], v[80:83], a[32:35]
ds_read_b64_tr_b16 v[170:171], v26 offset:512
v_mfma_f32_16x16x32_bf16 a[32:35], v[112:115], v[84:87], a[32:35]
ds_read_b128 v[128:131], v22
s_waitcnt lgkmcnt(12)
v_mfma_f32_16x16x32_bf16 a[32:35], v[120:123], v[88:91], a[32:35]
ds_read_b64_tr_b16 v[176:177], v26 offset:1024
s_waitcnt lgkmcnt(12)
v_mfma_f32_16x16x32_bf16 a[40:43], v[120:123], v[92:95], a[40:43]
ds_read_b64_tr_b16 v[178:179], v26 offset:1536
v_mfma_f32_16x16x32_bf16 a[40:43], v[112:115], v[88:91], a[40:43]
ds_read_b128 v[132:135], v21 offset:0
v_mfma_f32_16x16x32_bf16 a[40:43], v[104:107], v[84:87], a[40:43]
ds_read_b64_tr_b16 v[184:185], v26 offset:2048
v_mfma_f32_16x16x32_bf16 a[48:51], v[104:107], v[88:91], a[48:51]
ds_read_b64_tr_b16 v[186:187], v26 offset:2560
v_mfma_f32_16x16x32_bf16 a[48:51], v[112:115], v[92:95], a[48:51]
ds_read_b128 v[136:139], v21 offset:2048
s_waitcnt lgkmcnt(14)
v_mfma_f32_16x16x32_bf16 a[48:51], v[120:123], v[96:99], a[48:51]
ds_read_b128 v[140:143], v21 offset:4096
v_mfma_f32_16x16x32_bf16 a[56:59], v[120:123], v[100:103], a[56:59]
ds_read_b128 v[144:147], v21 offset:6144
v_mfma_f32_16x16x32_bf16 a[56:59], v[112:115], v[96:99], a[56:59]
ds_read_b128 v[148:151], v21 offset:8192
v_mfma_f32_16x16x32_bf16 a[56:59], v[104:107], v[92:95], a[56:59]
ds_read_b128 v[152:155], v21 offset:10240
s_waitcnt lgkmcnt(14)
v_mfma_f32_16x16x32_bf16 a[60:63], v[108:111], v[92:95], a[60:63]
ds_read_b128 v[156:159], v21 offset:12288
v_mfma_f32_16x16x32_bf16 a[60:63], v[116:119], v[96:99], a[60:63]
ds_read_b128 v[160:163], v21 offset:14336
s_waitcnt lgkmcnt(14)
v_mfma_f32_16x16x32_bf16 a[60:63], v[124:127], v[100:103], a[60:63]
ds_read_b128 v[164:167], v23
v_mfma_f32_16x16x32_bf16 a[52:55], v[124:127], v[96:99], a[52:55]
ds_read_b64_tr_b16 v[172:173], v27 offset:0
v_mfma_f32_16x16x32_bf16 a[52:55], v[116:119], v[92:95], a[52:55]
ds_read_b64_tr_b16 v[174:175], v27 offset:512
v_mfma_f32_16x16x32_bf16 a[52:55], v[108:111], v[88:91], a[52:55]
ds_read_b64_tr_b16 v[180:181], v27 offset:1024
v_mfma_f32_16x16x32_bf16 a[44:47], v[108:111], v[84:87], a[44:47]
ds_read_b64_tr_b16 v[182:183], v27 offset:1536
v_mfma_f32_16x16x32_bf16 a[44:47], v[116:119], v[88:91], a[44:47]
ds_read_b64_tr_b16 v[188:189], v27 offset:2048
v_mfma_f32_16x16x32_bf16 a[44:47], v[124:127], v[92:95], a[44:47]
ds_read_b64_tr_b16 v[190:191], v27 offset:2560
v_mfma_f32_16x16x32_bf16 a[36:39], v[124:127], v[88:91], a[36:39]
s_add_u32 s28, s28, 32768
s_cmp_eq_u32 s28, 98304
s_cselect_b32 s28, 0, s28
v_mfma_f32_16x16x32_bf16 a[36:39], v[116:119], v[84:87], a[36:39]
s_add_u32 s30, s30, 12288
s_cmp_eq_u32 s30, 163840
s_cselect_b32 s30, 102400, s30
v_mfma_f32_16x16x32_bf16 a[36:39], v[108:111], v[80:83], a[36:39]
s_add_u32 s33, s33, 256
s_and_b32 s33, s33, 0xf00
s_or_b32 s34, s28, s33
v_mfma_f32_16x16x32_bf16 a[28:31], v[108:111], v[76:79], a[28:31]
v_or_b32 v21, s28, v16
v_mfma_f32_16x16x32_bf16 a[28:31], v[116:119], v[80:83], a[28:31]
v_and_or_b32 v22, s34, v19, v17
v_mfma_f32_16x16x32_bf16 a[28:31], v[124:127], v[84:87], a[28:31]
v_and_or_b32 v23, s34, v20, v18
v_mfma_f32_16x16x32_bf16 a[20:23], v[124:127], v[80:83], a[20:23]
v_add_u32 v26, s30, v24
v_mfma_f32_16x16x32_bf16 a[20:23], v[116:119], v[76:79], a[20:23]
v_add_u32 v27, s30, v25
s_waitcnt lgkmcnt(0)
v_mfma_f32_16x16x32_bf16 a[20:23], v[108:111], v[72:75], a[20:23]
v_mfma_f32_16x16x32_bf16 a[12:15], v[108:111], v[68:71], a[12:15]
v_mfma_f32_16x16x32_bf16 a[12:15], v[116:119], v[72:75], a[12:15]
v_mfma_f32_16x16x32_bf16 a[12:15], v[124:127], v[76:79], a[12:15]
v_mfma_f32_16x16x32_bf16 a[4:7], v[124:127], v[72:75], a[4:7]
v_mfma_f32_16x16x32_bf16 a[4:7], v[116:119], v[68:71], a[4:7]
s_add_u32 s27, s27, 1
s_cmp_lt_u32 s27, 14
v_mfma_f32_16x16x32_bf16 a[4:7], v[108:111], v[64:67], a[4:7]
s_cbranch_scc1 L_loop
L_touch:
s_cbranch_scc1 L_ret
s_barrier
v_mfma_f32_16x16x32_bf16 a[0:3], v[168:171], v[128:131], a[0:3]
ds_read_b64_tr_b16 v[32:33], v26 offset:0
v_xor_b32 v16, 64, v21
v_mfma_f32_16x16x32_bf16 a[0:3], v[176:179], v[132:135], a[0:3]
ds_read_b64_tr_b16 v[34:35], v26 offset:512
v_xor_b32 v17, 64, v22
v_mfma_f32_16x16x32_bf16 a[0:3], v[184:187], v[136:139], a[0:3]
ds_read_b128 v[36:39], v22
v_xor_b32 v18, 64, v23
v_mfma_f32_16x16x32_bf16 a[4:7], v[188:191], v[136:139], a[4:7]
ds_read_b64_tr_b16 v[40:41], v26 offset:1024
v_mfma_f32_16x16x32_bf16 a[4:7], v[180:183], v[132:135], a[4:7]
ds_read_b64_tr_b16 v[42:43], v26 offset:1536
v_mfma_f32_16x16x32_bf16 a[4:7], v[172:175], v[128:131], a[4:7]
ds_read_b128 v[44:47], v21 offset:0
v_mfma_f32_16x16x32_bf16 a[12:15], v[172:175], v[132:135], a[12:15]
ds_read_b64_tr_b16 v[48:49], v26 offset:2048
v_mfma_f32_16x16x32_bf16 a[12:15], v[180:183], v[136:139], a[12:15]
ds_read_b64_tr_b16 v[50:51], v26 offset:2560
v_mfma_f32_16x16x32_bf16 a[12:15], v[188:191], v[140:143], a[12:15]
ds_read_b128 v[52:55], v21 offset:2048
v_mfma_f32_16x16x32_bf16 a[8:11], v[184:187], v[140:143], a[8:11]
ds_read_b64_tr_b16 v[56:57], v27 offset:2048
v_mfma_f32_16x16x32_bf16 a[8:11], v[176:179], v[136:139], a[8:11]
ds_read_b64_tr_b16 v[58:59], v27 offset:2560
v_mfma_f32_16x16x32_bf16 a[8:11], v[168:171], v[132:135], a[8:11]
ds_read_b64_tr_b16 v[60:61], v27 offset:1024
v_mfma_f32_16x16x32_bf16 a[16:19], v[168:171], v[136:139], a[16:19]
ds_read_b64_tr_b16 v[62:63], v27 offset:1536
v_mfma_f32_16x16x32_bf16 a[16:19], v[176:179], v[140:143], a[16:19]
ds_read_b64_tr_b16 v[64:65], v27 offset:0
v_mfma_f32_16x16x32_bf16 a[16:19], v[184:187], v[144:147], a[16:19]
ds_read_b64_tr_b16 v[66:67], v27 offset:512
v_mfma_f32_16x16x32_bf16 a[20:23], v[188:191], v[144:147], a[20:23]
ds_read_b64_tr_b16 v[68:69], v27 offset:12288
v_mfma_f32_16x16x32_bf16 a[20:23], v[180:183], v[140:143], a[20:23]
ds_read_b64_tr_b16 v[70:71], v27 offset:12800
v_mfma_f32_16x16x32_bf16 a[20:23], v[172:175], v[136:139], a[20:23]
ds_read_b128 v[72:75], v17
v_mfma_f32_16x16x32_bf16 a[28:31], v[172:175], v[140:143], a[28:31]
ds_read_b64_tr_b16 v[76:77], v27 offset:13312
v_mfma_f32_16x16x32_bf16 a[28:31], v[180:183], v[144:147], a[28:31]
ds_read_b64_tr_b16 v[78:79], v27 offset:13824
v_mfma_f32_16x16x32_bf16 a[28:31], v[188:191], v[148:151], a[28:31]
ds_read_b128 v[80:83], v16 offset:0
v_mfma_f32_16x16x32_bf16 a[24:27], v[184:187], v[148:151], a[24:27]
ds_read_b64_tr_b16 v[84:85], v27 offset:14336
v_mfma_f32_16x16x32_bf16 a[24:27], v[176:179], v[144:147], a[24:27]
ds_read_b64_tr_b16 v[86:87], v27 offset:14848
v_mfma_f32_16x16x32_bf16 a[24:27], v[168:171], v[140:143], a[24:27]
ds_read_b128 v[88:91], v16 offset:2048
v_mfma_f32_16x16x32_bf16 a[32:35], v[168:171], v[144:147], a[32:35]
ds_read_b64_tr_b16 v[92:93], v26 offset:14336
v_mfma_f32_16x16x32_bf16 a[32:35], v[176:179], v[148:151], a[32:35]
ds_read_b64_tr_b16 v[94:95], v26 offset:14848
v_mfma_f32_16x16x32_bf16 a[32:35], v[184:187], v[152:155], a[32:35]
ds_read_b64_tr_b16 v[96:97], v26 offset:13312
v_mfma_f32_16x16x32_bf16 a[36:39], v[188:191], v[152:155], a[36:39]
ds_read_b64_tr_b16 v[98:99], v26 offset:13824
v_mfma_f32_16x16x32_bf16 a[36:39], v[180:183], v[148:151], a[36:39]
ds_read_b64_tr_b16 v[100:101], v26 offset:12288
v_mfma_f32_16x16x32_bf16 a[36:39], v[172:175], v[144:147], a[36:39]
s_barrier
v_mfma_f32_16x16x32_bf16 a[44:47], v[172:175], v[148:151], a[44:47]
ds_read_b64_tr_b16 v[102:103], v26 offset:12800
v_mfma_f32_16x16x32_bf16 a[44:47], v[180:183], v[152:155], a[44:47]
ds_read_b64_tr_b16 v[104:105], v14 offset:0
v_mfma_f32_16x16x32_bf16 a[44:47], v[188:191], v[156:159], a[44:47]
ds_read_b64_tr_b16 v[106:107], v14 offset:512
v_mfma_f32_16x16x32_bf16 a[40:43], v[184:187], v[156:159], a[40:43]
ds_read_b128 v[108:111], v9
v_mfma_f32_16x16x32_bf16 a[40:43], v[176:179], v[152:155], a[40:43]
ds_read_b64_tr_b16 v[112:113], v14 offset:1024
v_mfma_f32_16x16x32_bf16 a[40:43], v[168:171], v[148:151], a[40:43]
ds_read_b64_tr_b16 v[114:115], v14 offset:1536
v_mfma_f32_16x16x32_bf16 a[48:51], v[168:171], v[152:155], a[48:51]
ds_read_b128 v[116:119], v8 offset:0
v_mfma_f32_16x16x32_bf16 a[48:51], v[176:179], v[156:159], a[48:51]
ds_read_b64_tr_b16 v[120:121], v14 offset:2048
v_mfma_f32_16x16x32_bf16 a[48:51], v[184:187], v[160:163], a[48:51]
ds_read_b64_tr_b16 v[122:123], v14 offset:2560
v_mfma_f32_16x16x32_bf16 a[52:55], v[188:191], v[160:163], a[52:55]
ds_read_b128 v[124:127], v8 offset:2048
v_mfma_f32_16x16x32_bf16 a[52:55], v[180:183], v[156:159], a[52:55]
ds_read_b64_tr_b16 v[128:129], v15 offset:2048
v_mfma_f32_16x16x32_bf16 a[52:55], v[172:175], v[152:155], a[52:55]
ds_read_b64_tr_b16 v[130:131], v15 offset:2560
v_mfma_f32_16x16x32_bf16 a[60:63], v[172:175], v[156:159], a[60:63]
ds_read_b64_tr_b16 v[132:133], v15 offset:1024
v_mfma_f32_16x16x32_bf16 a[60:63], v[180:183], v[160:163], a[60:63]
ds_read_b64_tr_b16 v[134:135], v15 offset:1536
v_mfma_f32_16x16x32_bf16 a[60:63], v[188:191], v[164:167], a[60:63]
ds_read_b64_tr_b16 v[136:137], v15 offset:0
v_mfma_f32_16x16x32_bf16 a[56:59], v[184:187], v[164:167], a[56:59]
ds_read_b64_tr_b16 v[138:139], v15 offset:512
v_mfma_f32_16x16x32_bf16 a[56:59], v[176:179], v[160:163], a[56:59]
ds_read_b128 v[140:143], v12
v_mfma_f32_16x16x32_bf16 a[56:59], v[168:171], v[156:159], a[56:59]
s_barrier
s_waitcnt lgkmcnt(14)
v_mfma_f32_16x16x32_bf16 a[0:3], v[32:35], v[36:39], a[0:3]
ds_read_b64_tr_b16 v[144:145], v15 offset:12288
v_mfma_f32_16x16x32_bf16 a[0:3], v[40:43], v[44:47], a[0:3]
ds_read_b64_tr_b16 v[146:147], v15 offset:12800
v_mfma_f32_16x16x32_bf16 a[0:3], v[48:51], v[52:55], a[0:3]
ds_read_b64_tr_b16 v[148:149], v15 offset:13312
v_mfma_f32_16x16x32_bf16 a[4:7], v[56:59], v[52:55], a[4:7]
ds_read_b64_tr_b16 v[150:151], v15 offset:13824
v_mfma_f32_16x16x32_bf16 a[4:7], v[60:63], v[44:47], a[4:7]
ds_read_b128 v[152:155], v11 offset:0
v_mfma_f32_16x16x32_bf16 a[4:7], v[64:67], v[36:39], a[4:7]
ds_read_b64_tr_b16 v[172:173], v15 offset:14336
v_mfma_f32_16x16x32_bf16 a[4:7], v[68:71], v[72:75], a[4:7]
ds_read_b64_tr_b16 v[174:175], v15 offset:14848
v_mfma_f32_16x16x32_bf16 a[4:7], v[76:79], v[80:83], a[4:7]
ds_read_b128 v[180:183], v11 offset:2048
v_mfma_f32_16x16x32_bf16 a[4:7], v[84:87], v[88:91], a[4:7]
ds_read_b64_tr_b16 v[188:189], v14 offset:14336
v_mfma_f32_16x16x32_bf16 a[0:3], v[92:95], v[88:91], a[0:3]
ds_read_b64_tr_b16 v[190:191], v14 offset:14848
v_mfma_f32_16x16x32_bf16 a[0:3], v[96:99], v[80:83], a[0:3]
ds_read_b64_tr_b16 v[164:165], v14 offset:13312
v_mfma_f32_16x16x32_bf16 a[0:3], v[100:103], v[72:75], a[0:3]
ds_read_b64_tr_b16 v[166:167], v14 offset:13824
s_waitcnt lgkmcnt(14)
v_mfma_f32_16x16x32_bf16 a[0:3], v[104:107], v[108:111], a[0:3]
ds_read_b64_tr_b16 v[184:185], v14 offset:12288
v_mfma_f32_16x16x32_bf16 a[0:3], v[112:115], v[116:119], a[0:3]
ds_read_b64_tr_b16 v[186:187], v14 offset:12800
v_mfma_f32_16x16x32_bf16 a[0:3], v[120:123], v[124:127], a[0:3]
ds_read_b128 v[160:163], v21 offset:4096
v_mfma_f32_16x16x32_bf16 a[4:7], v[128:131], v[124:127], a[4:7]
ds_read_b128 v[176:179], v16 offset:4096
v_mfma_f32_16x16x32_bf16 a[4:7], v[132:135], v[116:119], a[4:7]
ds_read_b128 v[156:159], v8 offset:4096
s_waitcnt lgkmcnt(14)
v_mfma_f32_16x16x32_bf16 a[4:7], v[136:139], v[108:111], a[4:7]
ds_read_b128 v[168:171], v11 offset:4096
v_mfma_f32_16x16x32_bf16 a[4:7], v[144:147], v[140:143], a[4:7]
s_waitcnt lgkmcnt(13)
v_mfma_f32_16x16x32_bf16 a[4:7], v[148:151], v[152:155], a[4:7]
s_waitcnt lgkmcnt(10)
v_mfma_f32_16x16x32_bf16 a[4:7], v[172:175], v[180:183], a[4:7]
s_waitcnt lgkmcnt(8)
v_mfma_f32_16x16x32_bf16 a[0:3], v[188:191], v[180:183], a[0:3]
s_waitcnt lgkmcnt(6)
v_mfma_f32_16x16x32_bf16 a[0:3], v[164:167], v[152:155], a[0:3]
s_waitcnt lgkmcnt(4)
v_mfma_f32_16x16x32_bf16 a[0:3], v[184:187], v[140:143], a[0:3]
v_mfma_f32_16x16x32_bf16 a[8:11], v[32:35], v[44:47], a[8:11]
ds_read_b128 v[36:39], v21 offset:6144
v_mfma_f32_16x16x32_bf16 a[8:11], v[40:43], v[52:55], a[8:11]
ds_read_b128 v[72:75], v16 offset:6144
s_waitcnt lgkmcnt(5)
v_mfma_f32_16x16x32_bf16 a[8:11], v[48:51], v[160:163], a[8:11]
ds_read_b128 v[108:111], v8 offset:6144
v_mfma_f32_16x16x32_bf16 a[8:11], v[100:103], v[80:83], a[8:11]
ds_read_b128 v[140:143], v11 offset:6144
v_mfma_f32_16x16x32_bf16 a[8:11], v[96:99], v[88:91], a[8:11]
ds_write_b128 v29, a[4:7] offset:0
s_waitcnt lgkmcnt(7)
v_mfma_f32_16x16x32_bf16 a[8:11], v[92:95], v[176:179], a[8:11]
v_mfma_f32_16x16x32_bf16 a[8:11], v[104:107], v[116:119], a[8:11]
v_mfma_f32_16x16x32_bf16 a[8:11], v[112:115], v[124:127], a[8:11]
ds_write_b128 v28, a[0:3] offset:0
s_waitcnt lgkmcnt(7)
v_mfma_f32_16x16x32_bf16 a[8:11], v[120:123], v[156:159], a[8:11]
v_mfma_f32_16x16x32_bf16 a[8:11], v[184:187], v[152:155], a[8:11]
v_mfma_f32_16x16x32_bf16 a[8:11], v[164:167], v[180:183], a[8:11]
s_waitcnt lgkmcnt(6)
v_mfma_f32_16x16x32_bf16 a[8:11], v[188:191], v[168:171], a[8:11]
v_mfma_f32_16x16x32_bf16 a[12:15], v[172:175], v[168:171], a[12:15]
v_mfma_f32_16x16x32_bf16 a[12:15], v[148:151], v[180:183], a[12:15]
s_waitcnt lgkmcnt(0)
s_barrier
v_mfma_f32_16x16x32_bf16 a[12:15], v[144:147], v[152:155], a[12:15]
v_mfma_f32_16x16x32_bf16 a[12:15], v[128:131], v[156:159], a[12:15]
v_mfma_f32_16x16x32_bf16 a[12:15], v[132:135], v[124:127], a[12:15]
v_mfma_f32_16x16x32_bf16 a[12:15], v[136:139], v[116:119], a[12:15]
v_mfma_f32_16x16x32_bf16 a[12:15], v[84:87], v[176:179], a[12:15]
v_mfma_f32_16x16x32_bf16 a[12:15], v[76:79], v[88:91], a[12:15]
ds_write_b128 v28, a[8:11] offset:8192
v_mfma_f32_16x16x32_bf16 a[12:15], v[68:71], v[80:83], a[12:15]
v_mfma_f32_16x16x32_bf16 a[12:15], v[56:59], v[160:163], a[12:15]
v_mfma_f32_16x16x32_bf16 a[12:15], v[60:63], v[52:55], a[12:15]
v_mfma_f32_16x16x32_bf16 a[12:15], v[64:67], v[44:47], a[12:15]
v_mfma_f32_16x16x32_bf16 a[20:23], v[64:67], v[52:55], a[20:23]
ds_read_b128 v[152:155], v21 offset:8192
v_mfma_f32_16x16x32_bf16 a[20:23], v[60:63], v[160:163], a[20:23]
ds_read_b128 v[116:119], v16 offset:8192
v_mfma_f32_16x16x32_bf16 a[20:23], v[56:59], v[36:39], a[20:23]
ds_read_b128 v[80:83], v8 offset:8192
v_mfma_f32_16x16x32_bf16 a[20:23], v[68:71], v[88:91], a[20:23]
ds_read_b128 v[44:47], v11 offset:8192
v_mfma_f32_16x16x32_bf16 a[20:23], v[76:79], v[176:179], a[20:23]
v_mfma_f32_16x16x32_bf16 a[20:23], v[84:87], v[72:75], a[20:23]
v_mfma_f32_16x16x32_bf16 a[20:23], v[136:139], v[124:127], a[20:23]
v_mfma_f32_16x16x32_bf16 a[20:23], v[132:135], v[156:159], a[20:23]
ds_write_b128 v29, a[12:15] offset:8192
v_mfma_f32_16x16x32_bf16 a[20:23], v[128:131], v[108:111], a[20:23]
v_mfma_f32_16x16x32_bf16 a[20:23], v[144:147], v[180:183], a[20:23]
v_mfma_f32_16x16x32_bf16 a[20:23], v[148:151], v[168:171], a[20:23]
v_mfma_f32_16x16x32_bf16 a[20:23], v[172:175], v[140:143], a[20:23]
v_mfma_f32_16x16x32_bf16 a[16:19], v[188:191], v[140:143], a[16:19]
v_mfma_f32_16x16x32_bf16 a[16:19], v[164:167], v[168:171], a[16:19]
s_waitcnt lgkmcnt(0)
s_barrier
v_mfma_f32_16x16x32_bf16 a[16:19], v[184:187], v[180:183], a[16:19]
v_mfma_f32_16x16x32_bf16 a[16:19], v[120:123], v[108:111], a[16:19]
v_mfma_f32_16x16x32_bf16 a[16:19], v[112:115], v[156:159], a[16:19]
v_mfma_f32_16x16x32_bf16 a[16:19], v[104:107], v[124:127], a[16:19]
v_mfma_f32_16x16x32_bf16 a[16:19], v[92:95], v[72:75], a[16:19]
v_mfma_f32_16x16x32_bf16 a[16:19], v[96:99], v[176:179], a[16:19]
ds_write_b128 v29, a[20:23] offset:16384
v_mfma_f32_16x16x32_bf16 a[16:19], v[100:103], v[88:91], a[16:19]
v_mfma_f32_16x16x32_bf16 a[16:19], v[48:51], v[36:39], a[16:19]
v_mfma_f32_16x16x32_bf16 a[16:19], v[40:43], v[160:163], a[16:19]
v_mfma_f32_16x16x32_bf16 a[16:19], v[32:35], v[52:55], a[16:19]
v_mfma_f32_16x16x32_bf16 a[24:27], v[32:35], v[160:163], a[24:27]
ds_read_b128 v[180:183], v21 offset:10240
v_mfma_f32_16x16x32_bf16 a[24:27], v[40:43], v[36:39], a[24:27]
ds_read_b128 v[124:127], v16 offset:10240
v_mfma_f32_16x16x32_bf16 a[24:27], v[48:51], v[152:155], a[24:27]
ds_read_b128 v[88:91], v8 offset:10240
v_mfma_f32_16x16x32_bf16 a[24:27], v[100:103], v[176:179], a[24:27]
ds_read_b128 v[52:55], v11 offset:10240
v_mfma_f32_16x16x32_bf16 a[24:27], v[96:99], v[72:75], a[24:27]
v_mfma_f32_16x16x32_bf16 a[24:27], v[92:95], v[116:119], a[24:27]
v_mfma_f32_16x16x32_bf16 a[24:27], v[104:107], v[156:159], a[24:27]
v_mfma_f32_16x16x32_bf16 a[24:27], v[112:115], v[108:111], a[24:27]
ds_write_b128 v28, a[16:19] offset:16384
v_mfma_f32_16x16x32_bf16 a[24:27], v[120:123], v[80:83], a[24:27]
v_mfma_f32_16x16x32_bf16 a[24:27], v[184:187], v[168:171], a[24:27]
v_mfma_f32_16x16x32_bf16 a[24:27], v[164:167], v[140:143], a[24:27]
v_mfma_f32_16x16x32_bf16 a[24:27], v[188:191], v[44:47], a[24:27]
v_mfma_f32_16x16x32_bf16 a[28:31], v[172:175], v[44:47], a[28:31]
v_mfma_f32_16x16x32_bf16 a[28:31], v[148:151], v[140:143], a[28:31]
s_waitcnt lgkmcnt(0)
s_barrier
v_mfma_f32_16x16x32_bf16 a[28:31], v[144:147], v[168:171], a[28:31]
v_mfma_f32_16x16x32_bf16 a[28:31], v[128:131], v[80:83], a[28:31]
v_mfma_f32_16x16x32_bf16 a[28:31], v[132:135], v[108:111], a[28:31]
v_mfma_f32_16x16x32_bf16 a[28:31], v[136:139], v[156:159], a[28:31]
v_mfma_f32_16x16x32_bf16 a[28:31], v[84:87], v[116:119], a[28:31]
v_mfma_f32_16x16x32_bf16 a[28:31], v[76:79], v[72:75], a[28:31]
ds_write_b128 v28, a[24:27] offset:24576
v_mfma_f32_16x16x32_bf16 a[28:31], v[68:71], v[176:179], a[28:31]
v_mfma_f32_16x16x32_bf16 a[28:31], v[56:59], v[152:155], a[28:31]
v_mfma_f32_16x16x32_bf16 a[28:31], v[60:63], v[36:39], a[28:31]
v_mfma_f32_16x16x32_bf16 a[28:31], v[64:67], v[160:163], a[28:31]
v_mfma_f32_16x16x32_bf16 a[36:39], v[64:67], v[36:39], a[36:39]
ds_read_b128 v[168:171], v21 offset:12288
v_mfma_f32_16x16x32_bf16 a[36:39], v[60:63], v[152:155], a[36:39]
ds_read_b128 v[156:159], v16 offset:12288
v_mfma_f32_16x16x32_bf16 a[36:39], v[56:59], v[180:183], a[36:39]
ds_read_b128 v[176:179], v8 offset:12288
v_mfma_f32_16x16x32_bf16 a[36:39], v[68:71], v[72:75], a[36:39]
ds_read_b128 v[160:163], v11 offset:12288
v_mfma_f32_16x16x32_bf16 a[36:39], v[76:79], v[116:119], a[36:39]
v_mfma_f32_16x16x32_bf16 a[36:39], v[84:87], v[124:127], a[36:39]
v_mfma_f32_16x16x32_bf16 a[36:39], v[136:139], v[108:111], a[36:39]
v_mfma_f32_16x16x32_bf16 a[36:39], v[132:135], v[80:83], a[36:39]
ds_write_b128 v29, a[28:31] offset:24576
v_mfma_f32_16x16x32_bf16 a[36:39], v[128:131], v[88:91], a[36:39]
v_mfma_f32_16x16x32_bf16 a[36:39], v[144:147], v[140:143], a[36:39]
v_mfma_f32_16x16x32_bf16 a[36:39], v[148:151], v[44:47], a[36:39]
v_mfma_f32_16x16x32_bf16 a[36:39], v[172:175], v[52:55], a[36:39]
v_mfma_f32_16x16x32_bf16 a[32:35], v[188:191], v[52:55], a[32:35]
v_mfma_f32_16x16x32_bf16 a[32:35], v[164:167], v[44:47], a[32:35]
s_waitcnt lgkmcnt(0)
s_barrier
v_mfma_f32_16x16x32_bf16 a[32:35], v[184:187], v[140:143], a[32:35]
v_mfma_f32_16x16x32_bf16 a[32:35], v[120:123], v[88:91], a[32:35]
v_mfma_f32_16x16x32_bf16 a[32:35], v[112:115], v[80:83], a[32:35]
v_mfma_f32_16x16x32_bf16 a[32:35], v[104:107], v[108:111], a[32:35]
v_mfma_f32_16x16x32_bf16 a[32:35], v[92:95], v[124:127], a[32:35]
v_mfma_f32_16x16x32_bf16 a[32:35], v[96:99], v[116:119], a[32:35]
ds_write_b128 v29, a[36:39] offset:0
v_mfma_f32_16x16x32_bf16 a[32:35], v[100:103], v[72:75], a[32:35]
v_mfma_f32_16x16x32_bf16 a[32:35], v[48:51], v[180:183], a[32:35]
v_mfma_f32_16x16x32_bf16 a[32:35], v[40:43], v[152:155], a[32:35]
v_mfma_f32_16x16x32_bf16 a[32:35], v[32:35], v[36:39], a[32:35]
v_mfma_f32_16x16x32_bf16 a[40:43], v[32:35], v[152:155], a[40:43]
ds_read_b128 v[140:143], v21 offset:14336
v_mfma_f32_16x16x32_bf16 a[40:43], v[40:43], v[180:183], a[40:43]
ds_read_b128 v[108:111], v16 offset:14336
v_mfma_f32_16x16x32_bf16 a[40:43], v[48:51], v[168:171], a[40:43]
ds_read_b128 v[72:75], v8 offset:14336
v_mfma_f32_16x16x32_bf16 a[40:43], v[100:103], v[116:119], a[40:43]
ds_read_b128 v[36:39], v11 offset:14336
v_mfma_f32_16x16x32_bf16 a[40:43], v[96:99], v[124:127], a[40:43]
v_mfma_f32_16x16x32_bf16 a[40:43], v[92:95], v[156:159], a[40:43]
v_mfma_f32_16x16x32_bf16 a[40:43], v[104:107], v[80:83], a[40:43]
v_mfma_f32_16x16x32_bf16 a[40:43], v[112:115], v[88:91], a[40:43]
ds_write_b128 v28, a[32:35] offset:0
v_mfma_f32_16x16x32_bf16 a[40:43], v[120:123], v[176:179], a[40:43]
v_mfma_f32_16x16x32_bf16 a[40:43], v[184:187], v[44:47], a[40:43]
v_mfma_f32_16x16x32_bf16 a[40:43], v[164:167], v[52:55], a[40:43]
v_mfma_f32_16x16x32_bf16 a[40:43], v[188:191], v[160:163], a[40:43]
v_mfma_f32_16x16x32_bf16 a[44:47], v[172:175], v[160:163], a[44:47]
v_mfma_f32_16x16x32_bf16 a[44:47], v[148:151], v[52:55], a[44:47]
s_waitcnt lgkmcnt(0)
s_barrier
v_mfma_f32_16x16x32_bf16 a[44:47], v[144:147], v[44:47], a[44:47]
v_mfma_f32_16x16x32_bf16 a[44:47], v[128:131], v[176:179], a[44:47]
v_mfma_f32_16x16x32_bf16 a[44:47], v[132:135], v[88:91], a[44:47]
v_mfma_f32_16x16x32_bf16 a[44:47], v[136:139], v[80:83], a[44:47]
v_mfma_f32_16x16x32_bf16 a[44:47], v[84:87], v[156:159], a[44:47]
v_mfma_f32_16x16x32_bf16 a[44:47], v[76:79], v[124:127], a[44:47]
ds_write_b128 v28, a[40:43] offset:8192
v_mfma_f32_16x16x32_bf16 a[44:47], v[68:71], v[116:119], a[44:47]
v_mfma_f32_16x16x32_bf16 a[44:47], v[56:59], v[168:171], a[44:47]
v_mfma_f32_16x16x32_bf16 a[44:47], v[60:63], v[180:183], a[44:47]
v_mfma_f32_16x16x32_bf16 a[44:47], v[64:67], v[152:155], a[44:47]
v_mfma_f32_16x16x32_bf16 a[52:55], v[64:67], v[180:183], a[52:55]
ds_read_b128 v[44:47], v23
v_mfma_f32_16x16x32_bf16 a[52:55], v[60:63], v[168:171], a[52:55]
ds_read_b128 v[80:83], v18
v_mfma_f32_16x16x32_bf16 a[52:55], v[56:59], v[140:143], a[52:55]
ds_read_b128 v[116:119], v10
v_mfma_f32_16x16x32_bf16 a[52:55], v[68:71], v[124:127], a[52:55]
ds_read_b128 v[152:155], v13
v_mfma_f32_16x16x32_bf16 a[52:55], v[76:79], v[156:159], a[52:55]
v_mfma_f32_16x16x32_bf16 a[52:55], v[84:87], v[108:111], a[52:55]
v_mfma_f32_16x16x32_bf16 a[52:55], v[136:139], v[88:91], a[52:55]
v_mfma_f32_16x16x32_bf16 a[52:55], v[132:135], v[176:179], a[52:55]
ds_write_b128 v29, a[44:47] offset:8192
v_mfma_f32_16x16x32_bf16 a[52:55], v[128:131], v[72:75], a[52:55]
v_mfma_f32_16x16x32_bf16 a[52:55], v[144:147], v[52:55], a[52:55]
v_mfma_f32_16x16x32_bf16 a[52:55], v[148:151], v[160:163], a[52:55]
v_mfma_f32_16x16x32_bf16 a[52:55], v[172:175], v[36:39], a[52:55]
v_mfma_f32_16x16x32_bf16 a[48:51], v[188:191], v[36:39], a[48:51]
v_mfma_f32_16x16x32_bf16 a[48:51], v[164:167], v[160:163], a[48:51]
s_waitcnt lgkmcnt(0)
s_barrier
v_mfma_f32_16x16x32_bf16 a[48:51], v[184:187], v[52:55], a[48:51]
v_mfma_f32_16x16x32_bf16 a[48:51], v[120:123], v[72:75], a[48:51]
v_mfma_f32_16x16x32_bf16 a[48:51], v[112:115], v[176:179], a[48:51]
v_mfma_f32_16x16x32_bf16 a[48:51], v[104:107], v[88:91], a[48:51]
v_mfma_f32_16x16x32_bf16 a[48:51], v[92:95], v[108:111], a[48:51]
v_mfma_f32_16x16x32_bf16 a[48:51], v[96:99], v[156:159], a[48:51]
ds_write_b128 v29, a[52:55] offset:16384
v_mfma_f32_16x16x32_bf16 a[48:51], v[100:103], v[124:127], a[48:51]
v_mfma_f32_16x16x32_bf16 a[48:51], v[48:51], v[140:143], a[48:51]
v_mfma_f32_16x16x32_bf16 a[48:51], v[40:43], v[168:171], a[48:51]
v_mfma_f32_16x16x32_bf16 a[48:51], v[32:35], v[180:183], a[48:51]
v_mfma_f32_16x16x32_bf16 a[56:59], v[32:35], v[168:171], a[56:59]
v_mfma_f32_16x16x32_bf16 a[56:59], v[40:43], v[140:143], a[56:59]
v_mfma_f32_16x16x32_bf16 a[56:59], v[48:51], v[44:47], a[56:59]
v_mfma_f32_16x16x32_bf16 a[56:59], v[100:103], v[156:159], a[56:59]
v_mfma_f32_16x16x32_bf16 a[56:59], v[96:99], v[108:111], a[56:59]
v_mfma_f32_16x16x32_bf16 a[56:59], v[92:95], v[80:83], a[56:59]
v_mfma_f32_16x16x32_bf16 a[56:59], v[104:107], v[176:179], a[56:59]
v_mfma_f32_16x16x32_bf16 a[56:59], v[112:115], v[72:75], a[56:59]
ds_write_b128 v28, a[48:51] offset:16384
v_mfma_f32_16x16x32_bf16 a[56:59], v[120:123], v[116:119], a[56:59]
v_mfma_f32_16x16x32_bf16 a[56:59], v[184:187], v[160:163], a[56:59]
v_mfma_f32_16x16x32_bf16 a[56:59], v[164:167], v[36:39], a[56:59]
v_mfma_f32_16x16x32_bf16 a[56:59], v[188:191], v[152:155], a[56:59]
v_mfma_f32_16x16x32_bf16 a[60:63], v[172:175], v[152:155], a[60:63]
v_mfma_f32_16x16x32_bf16 a[60:63], v[148:151], v[36:39], a[60:63]
v_mfma_f32_16x16x32_bf16 a[60:63], v[144:147], v[160:163], a[60:63]
v_mfma_f32_16x16x32_bf16 a[60:63], v[128:131], v[116:119], a[60:63]
v_mfma_f32_16x16x32_bf16 a[60:63], v[132:135], v[72:75], a[60:63]
v_mfma_f32_16x16x32_bf16 a[60:63], v[136:139], v[176:179], a[60:63]
v_mfma_f32_16x16x32_bf16 a[60:63], v[84:87], v[80:83], a[60:63]
v_mfma_f32_16x16x32_bf16 a[60:63], v[76:79], v[108:111], a[60:63]
ds_write_b128 v28, a[56:59] offset:24576
v_mfma_f32_16x16x32_bf16 a[60:63], v[68:71], v[156:159], a[60:63]
v_mfma_f32_16x16x32_bf16 a[60:63], v[56:59], v[44:47], a[60:63]
v_mfma_f32_16x16x32_bf16 a[60:63], v[60:63], v[140:143], a[60:63]
v_mfma_f32_16x16x32_bf16 a[60:63], v[64:67], v[168:171], a[60:63]
s_nop 7
ds_write_b128 v29, a[60:63] offset:24576
s_waitcnt lgkmcnt(0)
s_barrier
L_end:
s_endpgm
.section .rodata,"a"
.p2align 6
.amdhsa_kernel standalone__batchnorm__prompt_kernel
  .amdhsa_next_free_vgpr 256
  .amdhsa_next_free_sgpr 102
  .amdhsa_accum_offset 192
  .amdhsa_group_segment_fixed_size 0
  .amdhsa_kernarg_size 72
  .amdhsa_user_sgpr_count 2
  .amdhsa_user_sgpr_kernarg_segment_ptr 1
  .amdhsa_system_sgpr_workgroup_id_x 1
.end_amdhsa_kernel
```
